```python
import torch

def _softmax(x, axis=-1):
    return torch.softmax(x, dim=axis)
def _gelu(x):
    return torch.nn.functional.gelu(x, approximate="tanh")
def _silu(x):
    return torch.nn.functional.silu(x)
def _sigmoid(x):
    return torch.sigmoid(x)
def _layernorm(x, axis=-1, eps=1e-5):
    m = x.mean(dim=axis, keepdim=True)
    v = x.var(dim=axis, keepdim=True, unbiased=False)
    return (x - m) / torch.sqrt(v + eps)
def _scatter_add(tgt, idx, src, axis=0):
    return tgt.clone().index_add_(axis, idx, src)
def _segment_sum(src, seg, n):
    out = torch.zeros((n,) + src.shape[1:], dtype=src.dtype)
    return out.index_add_(0, seg, src)
def _pad(x, pw):
    flat = tuple(v for pair in reversed(pw) for v in pair)
    return torch.nn.functional.pad(x, flat)

kernel_name = 'concat_heads__ssm_conv_s5__grouped_kv_mqa__prompt'

def setup_inputs():

    _w = (lambda a: (lambda t: t.to(torch.bfloat16) if t.is_floating_point() else t)(torch.as_tensor(a)))
    def _A_setup():
        B, S, D = 1, 2048, 448
        P = D
        Lambda_re = -0.5 * (lambda _x: torch.exp(torch.as_tensor(_x)))((lambda *s: torch.randn(*s, dtype=torch.bfloat16) * 0.4)(P))
        Lambda_im = (lambda *s: torch.randn(*s, dtype=torch.bfloat16) * 0.8)(P) * 1.0
        B_re = (lambda *s: torch.randn(*s, dtype=torch.bfloat16) * 0.4)(P, D) * (D ** -0.5)
        B_im = (lambda *s: torch.randn(*s, dtype=torch.bfloat16) * 0.4)(P, D) * (D ** -0.5)
        C_re = (lambda *s: torch.randn(*s, dtype=torch.bfloat16) * 0.4)(D, P) * (P ** -0.5)
        C_im = (lambda *s: torch.randn(*s, dtype=torch.bfloat16) * 0.4)(D, P) * (P ** -0.5)
        log_dt = (lambda *s: torch.randn(*s, dtype=torch.bfloat16) * 0.4)(P) * 0.3 - 2.0
        Dskip = (lambda *s: torch.randn(*s, dtype=torch.bfloat16) * 0.1)(D)
        return {
            "x": _w((lambda *s: torch.randn(*s, dtype=torch.bfloat16) * 0.05)(B, S, D)),
            "Lambda_re": _w(Lambda_re),
            "Lambda_im": _w(Lambda_im),
            "B_re": _w(B_re),
            "B_im": _w(B_im),
            "C_re": _w(C_re),
            "C_im": _w(C_im),
            "log_dt": _w(log_dt),
            "Dskip": _w(Dskip),
        }
    _A_in = _A_setup()

    def _B_setup():
        B, S, D, H = 1, 2048, 448, 16
        Dh = D // H
        return {
            "x": _w((lambda *s: torch.randn(*s, dtype=torch.bfloat16) * 0.05)(B, S, D)),
            "wq": _w((lambda *s: torch.randn(*s, dtype=torch.bfloat16) * 1.6)(D, H * Dh)),
            "wk": _w((lambda *s: torch.randn(*s, dtype=torch.bfloat16) * 1.6)(D, Dh)),
            "wv": _w((lambda *s: torch.randn(*s, dtype=torch.bfloat16) * 0.05)(D, Dh)),
            "wo": _w((lambda *s: torch.randn(*s, dtype=torch.bfloat16) * 0.05)(H * Dh, D)),
        }
    _B_in = _B_setup()

    return {
        "A_x": _A_in["x"],
        "A_Lambda_re": _A_in["Lambda_re"],
        "A_Lambda_im": _A_in["Lambda_im"],
        "A_B_re": _A_in["B_re"],
        "A_B_im": _A_in["B_im"],
        "A_C_re": _A_in["C_re"],
        "A_C_im": _A_in["C_im"],
        "A_log_dt": _A_in["log_dt"],
        "A_Dskip": _A_in["Dskip"],
        "B_x": _B_in["x"],
        "B_wq": _B_in["wq"],
        "B_wk": _B_in["wk"],
        "B_wv": _B_in["wv"],
        "B_wo": _B_in["wo"],
    }

def reference(A_x, A_Lambda_re, A_Lambda_im, A_B_re, A_B_im, A_C_re, A_C_im, A_log_dt, A_Dskip, B_x, B_wq, B_wk, B_wv, B_wo):
    def _A_ref(x, Lambda_re, Lambda_im, B_re, B_im, C_re, C_im, log_dt, Dskip):
        Bsz, L, H = x.shape
        Lam = Lambda_re + 1j * Lambda_im
        Bmat = B_re + 1j * B_im
        Cmat = C_re + 1j * C_im
        dt = torch.exp(log_dt)
        Lam_bar = torch.exp(dt * Lam)
        B_bar = ((Lam_bar - 1.0) / Lam)[:, None] * Bmat
        Bu = torch.einsum("bld,pd->blp", x + 0j, B_bar)
        h = torch.zeros_like(Bu[:, 0, :])
        hs = []
        for t in range(L):
            h = Lam_bar[None, :] * h + Bu[:, t, :]
            hs.append(h)
        hseq = torch.stack(hs, 1)
        y = 2.0 * torch.einsum("blp,dp->bld", hseq, Cmat).real + x * Dskip[None, None, :]
        return y

    def _B_ref(x, wq, wk, wv, wo):
        B, S, D = x.shape
        H = 16
        Dh = D // H
        q = (lambda x, *d: x.permute(*d))((x @ wq).reshape(B, S, H, Dh), 0, 2, 1, 3)
        k = x @ wk
        v = x @ wv
        scores = torch.einsum("bhqd,bkd->bhqk", q, k) * (Dh ** -0.5)
        p = _softmax(scores, axis=-1)
        o = torch.einsum("bhqk,bkd->bhqd", p, v)
        return (lambda x, *d: x.permute(*d))(o, 0, 2, 1, 3).reshape(B, S, H * Dh) @ wo

    a = _A_ref(A_x, A_Lambda_re, A_Lambda_im, A_B_re, A_B_im, A_C_re, A_C_im, A_log_dt, A_Dskip)
    b = _B_ref(B_x, B_wq, B_wk, B_wv, B_wo)
    return torch.concatenate([a, b], axis=-1)
```

```asm
; @launch grid=(512,1,1) block=(640,1,1) lds=81920
.amdgcn_target "amdgcn-amd-amdhsa--gfx950"
.text
.globl concat_heads__ssm_conv_s5__grouped_kv_mqa__prompt_kernel
.p2align 8
.type concat_heads__ssm_conv_s5__grouped_kv_mqa__prompt_kernel,@function
concat_heads__ssm_conv_s5__grouped_kv_mqa__prompt_kernel:
    v_readfirstlane_b32 s3, v0
    s_cmp_ge_u32 s2, 512
    s_cbranch_scc1 L_exit0
    s_lshr_b32 s3, s3, 6
    s_cmp_ge_u32 s2, 256
    s_cbranch_scc1 L_live
    s_cmp_lt_u32 s3, 4
    s_cbranch_scc1 L_live
L_exit0:
    s_endpgm
L_live:
    s_load_dwordx16 s[16:31], s[0:1], 0
    s_load_dwordx16 s[32:47], s[0:1], 64
    s_load_dwordx2 s[48:49], s[0:1], 128
    s_getpc_b64 s[50:51]
    v_lshlrev_b32 v126, 7, v0
    v_min_u32 v126, CODE_END - concat_heads__ssm_conv_s5__grouped_kv_mqa__prompt_kernel - 256, v126
    global_load_dword v126, v126, s[50:51]
    v_and_b32 v1, 63, v0
    s_and_b32 s4, s2, 7
    s_bfe_u32 s5, s2, 0x50003
    s_add_u32 s5, s5, 28
    s_and_b32 s5, s5, 31
    v_lshrrev_b32 v2, 3, v1
    v_mov_b32 v127, 0
    s_mov_b32 s100, 0
    s_mul_i32 s8, s5, 37
    s_lshr_b32 s8, s8, 8
    s_mul_i32 s7, s8, 7
    s_sub_u32 s7, s5, s7
    s_cmp_ge_u32 s5, 28
    s_cselect_b32 s8, s7, s8
    s_cselect_b32 s7, 7, s7
    s_lshl_b32 s6, s4, 2
    s_add_u32 s6, s6, s8
    s_lshl_b32 s9, s3, 12
    v_lshrrev_b32 v4, 4, v1
    v_and_b32 v3, 7, v1
    v_xor_b32 v3, v3, v4
    v_lshlrev_b32 v3, 4, v3
    s_mov_b32 s63, 0
    s_setprio 2
    s_cmp_ge_u32 s2, 256
    s_cbranch_scc1 L_roleB
    s_cmp_lt_u32 s5, 28
    s_cbranch_scc1 L_roleA
    s_mov_b32 s63, 2
    s_setprio 3
L_roleB:
    s_cmp_ge_u32 s3, 4
    s_cbranch_scc1 B_idle
    s_lshl_b32 s8, s3, 4
    v_add_u32 v6, s8, v2
    v_mul_u32_u24 v6, 896, v6
    v_add_u32 v4, v6, v3
    v_xor_b32 v5, 64, v4
    v_add_u32 v5, 6144, v5
    v_bfe_u32 v7, v1, 4, 1
    v_lshlrev_b32 v7, 2, v7
    v_and_b32 v8, 7, v1
    v_xor_b32 v7, v7, v8
    v_lshl_add_u32 v6, v7, 4, v6
    v_add_u32 v7, 8192, v6
    v_add_u32 v6, 2048, v6
    s_mul_i32 s12, s6, 57344
    s_and_b32 s8, s6, 3
    s_lshl_b32 s8, s8, 1
    s_add_u32 s15, s7, s8
    s_cmp_ge_u32 s15, 7
    s_cselect_b32 s8, 7, 0
    s_sub_u32 s15, s15, s8
    s_mul_i32 s13, s7, 112
    s_lshl_b32 s8, s3, 4
    v_lshrrev_b32 v8, 2, v1
    v_add_u32 v8, s8, v8
    v_mul_u32_u24 v8, 56, v8
    v_and_b32 v9, 3, v1
    v_lshl_add_u32 v8, v9, 4, v8
    v_add_u32 v9, 1024, v8
    v_add_u32 v8, 2048, v8
    s_mov_b32 s50, 57344
    s_mov_b32 s58, 405504
    s_cmp_lg_u32 s63, 0
    s_cselect_b64 vcc, -1, 0
    s_cselect_b32 s50, 3584, s50
    s_cselect_b32 s13, 0, s13
    s_cselect_b32 s58, 29184, s58
    s_mov_b32 s74, s58
    s_mov_b32 s59, 0x00020000
    s_mov_b32 s75, 0x00020000
    v_cndmask_b32 v6, v6, v8, vcc
    v_cndmask_b32 v7, v7, v9, vcc
    s_mov_b32 s54, 1835008
    s_mov_b32 s55, 0x00020000
    s_waitcnt lgkmcnt(0)
    s_mov_b64 s[52:53], s[34:35]
    s_cselect_b64 s[56:57], s[38:39], s[36:37]
    s_cselect_b64 s[72:73], s[40:41], s[36:37]
    s_sub_u32 s56, s56, 4096
    s_subb_u32 s57, s57, 0
    s_sub_u32 s72, s72, 4096
    s_subb_u32 s73, s73, 0
    s_add_u32 m0, s9, 0
    s_lshl_b32 s8, s15, 7
    s_add_u32 s14, s12, s8
    buffer_load_dwordx4 v4, s[52:55], s14 offen lds
    buffer_load_dwordx4 v5, s[52:55], s14 offen offset:1024 lds
    s_mul_i32 s8, s15, s50
    s_add_u32 s14, s13, s8
    buffer_load_dwordx4 v6, s[56:59], s14 offen offset:2048 lds
    buffer_load_dwordx4 v7, s[72:75], s14 offen offset:3072 lds
    s_add_u32 s15, s15, 1
    s_cmp_eq_u32 s15, 7
    s_cselect_b32 s15, 0, s15
    s_mov_b32 s68, s46
    s_mov_b32 s69, s47
    s_mov_b32 s70, 0x100
    s_mov_b32 s71, 0x00020000
    s_lshl_b32 s8, s2, 2
    s_add_u32 s8, s8, s3
    s_cmp_lg_u32 s8, 3
    s_cbranch_scc1 B_notok
    s_memrealtime s[60:61]
    s_waitcnt lgkmcnt(0)
    s_or_b32 s61, s61, 0x80000000
    v_mov_b32 v8, s60
    v_mov_b32 v9, s61
    s_mov_b64 exec, 1
    buffer_store_dwordx2 v[8:9], v127, s[68:71], 0 offen sc1
    s_mov_b64 exec, -1
B_notok:
    s_add_u32 m0, s9, 16384
    s_lshl_b32 s8, s15, 7
    s_add_u32 s14, s12, s8
    buffer_load_dwordx4 v4, s[52:55], s14 offen lds
    buffer_load_dwordx4 v5, s[52:55], s14 offen offset:1024 lds
    s_mul_i32 s8, s15, s50
    s_add_u32 s14, s13, s8
    buffer_load_dwordx4 v6, s[56:59], s14 offen offset:2048 lds
    buffer_load_dwordx4 v7, s[72:75], s14 offen offset:3072 lds
    s_add_u32 s15, s15, 1
    s_cmp_eq_u32 s15, 7
    s_cselect_b32 s15, 0, s15
    s_add_u32 m0, s9, 32768
    s_lshl_b32 s8, s15, 7
    s_add_u32 s14, s12, s8
    buffer_load_dwordx4 v4, s[52:55], s14 offen lds
    buffer_load_dwordx4 v5, s[52:55], s14 offen offset:1024 lds
    s_mul_i32 s8, s15, s50
    s_add_u32 s14, s13, s8
    buffer_load_dwordx4 v6, s[56:59], s14 offen offset:2048 lds
    buffer_load_dwordx4 v7, s[72:75], s14 offen offset:3072 lds
    s_add_u32 s15, s15, 1
    s_cmp_eq_u32 s15, 7
    s_cselect_b32 s15, 0, s15
    s_add_u32 m0, s9, 49152
    s_lshl_b32 s8, s15, 7
    s_add_u32 s14, s12, s8
    buffer_load_dwordx4 v4, s[52:55], s14 offen lds
    buffer_load_dwordx4 v5, s[52:55], s14 offen offset:1024 lds
    s_mul_i32 s8, s15, s50
    s_add_u32 s14, s13, s8
    buffer_load_dwordx4 v6, s[56:59], s14 offen offset:2048 lds
    buffer_load_dwordx4 v7, s[72:75], s14 offen offset:3072 lds
    s_add_u32 s15, s15, 1
    s_cmp_eq_u32 s15, 7
    s_cselect_b32 s15, 0, s15
    s_add_u32 m0, s9, 65536
    s_lshl_b32 s8, s15, 7
    s_add_u32 s14, s12, s8
    buffer_load_dwordx4 v4, s[52:55], s14 offen lds
    buffer_load_dwordx4 v5, s[52:55], s14 offen offset:1024 lds
    s_mul_i32 s8, s15, s50
    s_add_u32 s14, s13, s8
    buffer_load_dwordx4 v6, s[56:59], s14 offen offset:2048 lds
    buffer_load_dwordx4 v7, s[72:75], s14 offen offset:3072 lds
    s_add_u32 s15, s15, 1
    s_cmp_eq_u32 s15, 7
    s_cselect_b32 s15, 0, s15
    s_mov_b32 s64, s48
    s_mov_b32 s65, s49
    s_mov_b32 s66, 0x6f0000
    s_mov_b32 s67, 0x00020000
    s_and_b32 s8, s3, 1
    s_lshl_b32 s8, s8, 13
    v_bfe_u32 v8, v1, 4, 1
    v_lshlrev_b32 v9, 12, v8
    v_and_b32 v8, 15, v1
    v_lshl_add_u32 v9, v8, 7, v9
    v_add_u32 v9, s8, v9
    v_bfe_u32 v8, v1, 1, 3
    v_lshrrev_b32 v96, 5, v1
    v_xor_b32 v8, v8, v96
    v_xor_b32 v96, 0, v8
    v_lshl_add_u32 v96, v96, 4, v9
    v_xor_b32 v97, 2, v8
    v_lshl_add_u32 v97, v97, 4, v9
    v_xor_b32 v98, 4, v8
    v_lshl_add_u32 v98, v98, 4, v9
    v_xor_b32 v99, 6, v8
    v_lshl_add_u32 v99, v99, 4, v9
    s_lshr_b32 s61, s3, 1
    v_bfe_u32 v8, v1, 4, 1
    v_lshlrev_b32 v100, 5, v8
    v_and_b32 v8, 3, v1
    v_lshl_add_u32 v100, v8, 3, v100
    v_lshrrev_b32 v9, 5, v1
    v_bfe_u32 v8, v1, 2, 2
    s_cmp_lg_u32 s63, 0
    s_cbranch_scc1 B_takv
    s_mul_i32 s8, s61, 56
    v_add_u32 v100, s8, v100
    v_bfe_u32 v10, v1, 3, 1
    v_lshlrev_b32 v10, 6, v10
    v_xor_b32 v100, v100, v10
    v_lshl_add_u32 v100, v9, 10, v100
    v_lshl_add_u32 v100, v8, 7, v100
    v_add_u32 v100, 0x800, v100
    v_add_u32 v101, 512, v100
    s_mov_b32 s101, 0
B_tad:
    v_add_u32 v102, 0x10000, v96
    v_add_u32 v103, 0x10000, v97
    v_add_u32 v104, 0x10000, v98
    v_add_u32 v105, 0x10000, v99
    v_add_u32 v106, 0x10000, v100
    v_add_u32 v107, 0x10000, v101
    s_cmp_eq_u32 s101, 1
    s_cbranch_scc1 B_qv
    s_waitcnt vmcnt(12)
    s_barrier
    ds_read_b128 v[32:35], v96 offset:0
    ds_read_b64_tr_b16 v[36:37], v100 offset:0
    ds_read_b64_tr_b16 v[38:39], v101 offset:0
    ds_read_b128 v[40:43], v97 offset:0
    ds_read_b64_tr_b16 v[44:45], v100 offset:4096
    ds_read_b64_tr_b16 v[46:47], v101 offset:4096
    ds_read_b128 v[48:51], v98 offset:0
    ds_read_b64_tr_b16 v[52:53], v100 offset:8192
    ds_read_b64_tr_b16 v[54:55], v101 offset:8192
    ds_read_b128 v[56:59], v99 offset:0
    ds_read_b64_tr_b16 v[60:61], v100 offset:12288
    ds_read_b64_tr_b16 v[62:63], v101 offset:12288
    ds_read_b128 v[64:67], v96 offset:16384
    ds_read_b64_tr_b16 v[68:69], v100 offset:16384
    ds_read_b64_tr_b16 v[70:71], v101 offset:16384
    s_waitcnt lgkmcnt(12)
    v_mfma_f32_32x32x16_bf16 v[16:31], v[36:39], v[32:35], 0
    ds_read_b128 v[72:75], v97 offset:16384
    ds_read_b64_tr_b16 v[76:77], v100 offset:20480
    ds_read_b64_tr_b16 v[78:79], v101 offset:20480
    s_waitcnt lgkmcnt(12)
    v_mfma_f32_32x32x16_bf16 v[16:31], v[44:47], v[40:43], v[16:31]
    ds_read_b128 v[80:83], v98 offset:16384
    ds_read_b64_tr_b16 v[84:85], v100 offset:24576
    ds_read_b64_tr_b16 v[86:87], v101 offset:24576
    s_waitcnt lgkmcnt(12)
    v_mfma_f32_32x32x16_bf16 v[16:31], v[52:55], v[48:51], v[16:31]
    ds_read_b128 v[88:91], v99 offset:16384
    ds_read_b64_tr_b16 v[92:93], v100 offset:28672
    ds_read_b64_tr_b16 v[94:95], v101 offset:28672
    s_waitcnt lgkmcnt(12)
    v_mfma_f32_32x32x16_bf16 v[16:31], v[60:63], v[56:59], v[16:31]
    s_waitcnt lgkmcnt(9)
    v_mfma_f32_32x32x16_bf16 v[16:31], v[68:71], v[64:67], v[16:31]
    s_waitcnt lgkmcnt(6)
    v_mfma_f32_32x32x16_bf16 v[16:31], v[76:79], v[72:75], v[16:31]
    s_waitcnt lgkmcnt(3)
    v_mfma_f32_32x32x16_bf16 v[16:31], v[84:87], v[80:83], v[16:31]
    s_waitcnt lgkmcnt(0)
    v_mfma_f32_32x32x16_bf16 v[16:31], v[92:95], v[88:91], v[16:31]
    s_waitcnt vmcnt(0)
    s_barrier
    ds_read_b128 v[32:35], v96 offset:32768
    ds_read_b64_tr_b16 v[36:37], v100 offset:32768
    ds_read_b64_tr_b16 v[38:39], v101 offset:32768
    ds_read_b128 v[40:43], v97 offset:32768
    ds_read_b64_tr_b16 v[44:45], v100 offset:36864
    ds_read_b64_tr_b16 v[46:47], v101 offset:36864
    ds_read_b128 v[48:51], v98 offset:32768
    ds_read_b64_tr_b16 v[52:53], v100 offset:40960
    ds_read_b64_tr_b16 v[54:55], v101 offset:40960
    ds_read_b128 v[56:59], v99 offset:32768
    ds_read_b64_tr_b16 v[60:61], v100 offset:45056
    ds_read_b64_tr_b16 v[62:63], v101 offset:45056
    s_add_u32 m0, s9, 0
    s_lshl_b32 s8, s15, 7
    s_add_u32 s14, s12, s8
    buffer_load_dwordx4 v4, s[52:55], s14 offen lds
    buffer_load_dwordx4 v5, s[52:55], s14 offen offset:1024 lds
    s_mul_i32 s8, s15, s50
    s_add_u32 s14, s13, s8
    buffer_load_dwordx4 v6, s[56:59], s14 offen offset:2048 lds
    buffer_load_dwordx4 v7, s[72:75], s14 offen offset:3072 lds
    s_add_u32 s15, s15, 1
    s_cmp_eq_u32 s15, 7
    s_cselect_b32 s15, 0, s15
    s_add_u32 m0, s9, 16384
    s_lshl_b32 s8, s15, 7
    s_add_u32 s14, s12, s8
    buffer_load_dwordx4 v4, s[52:55], s14 offen lds
    buffer_load_dwordx4 v5, s[52:55], s14 offen offset:1024 lds
    s_mul_i32 s8, s15, s50
    s_add_u32 s14, s13, s8
    buffer_load_dwordx4 v6, s[56:59], s14 offen offset:2048 lds
    buffer_load_dwordx4 v7, s[72:75], s14 offen offset:3072 lds
    s_add_u32 s15, s15, 1
    s_cmp_eq_u32 s15, 7
    s_cselect_b32 s15, 0, s15
    buffer_load_dwordx2 v[124:125], v127, s[68:71], 0 offen sc1
    ds_read_b128 v[64:67], v96 offset:49152
    ds_read_b64_tr_b16 v[68:69], v100 offset:49152
    ds_read_b64_tr_b16 v[70:71], v101 offset:49152
    s_waitcnt lgkmcnt(12)
    v_mfma_f32_32x32x16_bf16 v[16:31], v[36:39], v[32:35], v[16:31]
    ds_read_b128 v[72:75], v97 offset:49152
    ds_read_b64_tr_b16 v[76:77], v100 offset:53248
    ds_read_b64_tr_b16 v[78:79], v101 offset:53248
    s_waitcnt lgkmcnt(12)
    v_mfma_f32_32x32x16_bf16 v[16:31], v[44:47], v[40:43], v[16:31]
    ds_read_b128 v[80:83], v98 offset:49152
    ds_read_b64_tr_b16 v[84:85], v100 offset:57344
    ds_read_b64_tr_b16 v[86:87], v101 offset:57344
    s_waitcnt lgkmcnt(12)
    v_mfma_f32_32x32x16_bf16 v[16:31], v[52:55], v[48:51], v[16:31]
    ds_read_b128 v[88:91], v99 offset:49152
    ds_read_b64_tr_b16 v[92:93], v100 offset:61440
    ds_read_b64_tr_b16 v[94:95], v101 offset:61440
    s_waitcnt lgkmcnt(12)
    v_mfma_f32_32x32x16_bf16 v[16:31], v[60:63], v[56:59], v[16:31]
    ds_read_b128 v[32:35], v102 offset:0
    ds_read_b64_tr_b16 v[36:37], v106 offset:0
    ds_read_b64_tr_b16 v[38:39], v107 offset:0
    s_waitcnt lgkmcnt(12)
    v_mfma_f32_32x32x16_bf16 v[16:31], v[68:71], v[64:67], v[16:31]
    ds_read_b128 v[40:43], v103 offset:0
    ds_read_b64_tr_b16 v[44:45], v106 offset:4096
    ds_read_b64_tr_b16 v[46:47], v107 offset:4096
    s_waitcnt lgkmcnt(12)
    v_mfma_f32_32x32x16_bf16 v[16:31], v[76:79], v[72:75], v[16:31]
    ds_read_b128 v[48:51], v104 offset:0
    ds_read_b64_tr_b16 v[52:53], v106 offset:8192
    ds_read_b64_tr_b16 v[54:55], v107 offset:8192
    s_waitcnt lgkmcnt(12)
    v_mfma_f32_32x32x16_bf16 v[16:31], v[84:87], v[80:83], v[16:31]
    ds_read_b128 v[56:59], v105 offset:0
    ds_read_b64_tr_b16 v[60:61], v106 offset:12288
    ds_read_b64_tr_b16 v[62:63], v107 offset:12288
    s_waitcnt lgkmcnt(12)
    v_mfma_f32_32x32x16_bf16 v[16:31], v[92:95], v[88:91], v[16:31]
    s_waitcnt lgkmcnt(9)
    v_mfma_f32_32x32x16_bf16 v[16:31], v[36:39], v[32:35], v[16:31]
    s_waitcnt lgkmcnt(6)
    v_mfma_f32_32x32x16_bf16 v[16:31], v[44:47], v[40:43], v[16:31]
    s_waitcnt lgkmcnt(3)
    v_mfma_f32_32x32x16_bf16 v[16:31], v[52:55], v[48:51], v[16:31]
    s_waitcnt lgkmcnt(0)
    v_mfma_f32_32x32x16_bf16 v[16:31], v[60:63], v[56:59], v[16:31]
    s_waitcnt vmcnt(5)
    s_barrier
    ds_read_b128 v[64:67], v96 offset:0
    ds_read_b64_tr_b16 v[68:69], v100 offset:0
    ds_read_b64_tr_b16 v[70:71], v101 offset:0
    ds_read_b128 v[72:75], v97 offset:0
    ds_read_b64_tr_b16 v[76:77], v100 offset:4096
    ds_read_b64_tr_b16 v[78:79], v101 offset:4096
    ds_read_b128 v[80:83], v98 offset:0
    ds_read_b64_tr_b16 v[84:85], v100 offset:8192
    ds_read_b64_tr_b16 v[86:87], v101 offset:8192
    ds_read_b128 v[88:91], v99 offset:0
    ds_read_b64_tr_b16 v[92:93], v100 offset:12288
    ds_read_b64_tr_b16 v[94:95], v101 offset:12288
    s_waitcnt lgkmcnt(9)
    v_mfma_f32_32x32x16_bf16 v[16:31], v[68:71], v[64:67], v[16:31]
    s_waitcnt lgkmcnt(6)
    v_mfma_f32_32x32x16_bf16 v[16:31], v[76:79], v[72:75], v[16:31]
    s_waitcnt lgkmcnt(3)
    v_mfma_f32_32x32x16_bf16 v[16:31], v[84:87], v[80:83], v[16:31]
    s_waitcnt lgkmcnt(0)
    v_mfma_f32_32x32x16_bf16 v[16:31], v[92:95], v[88:91], v[16:31]
    s_waitcnt vmcnt(1)
    s_barrier
    ds_read_b128 v[32:35], v96 offset:16384
    ds_read_b64_tr_b16 v[36:37], v100 offset:16384
    ds_read_b64_tr_b16 v[38:39], v101 offset:16384
    ds_read_b128 v[40:43], v97 offset:16384
    ds_read_b64_tr_b16 v[44:45], v100 offset:20480
    ds_read_b64_tr_b16 v[46:47], v101 offset:20480
    ds_read_b128 v[48:51], v98 offset:16384
    ds_read_b64_tr_b16 v[52:53], v100 offset:24576
    ds_read_b64_tr_b16 v[54:55], v101 offset:24576
    ds_read_b128 v[56:59], v99 offset:16384
    ds_read_b64_tr_b16 v[60:61], v100 offset:28672
    ds_read_b64_tr_b16 v[62:63], v101 offset:28672
    s_waitcnt lgkmcnt(9)
    v_mfma_f32_32x32x16_bf16 v[16:31], v[36:39], v[32:35], v[16:31]
    s_waitcnt lgkmcnt(6)
    v_mfma_f32_32x32x16_bf16 v[16:31], v[44:47], v[40:43], v[16:31]
    s_waitcnt lgkmcnt(3)
    v_mfma_f32_32x32x16_bf16 v[16:31], v[52:55], v[48:51], v[16:31]
    s_waitcnt lgkmcnt(0)
    v_mfma_f32_32x32x16_bf16 v[16:31], v[60:63], v[56:59], v[16:31]
    v_lshlrev_b32 v2, 4, v1
    s_cmp_lg_u32 s63, 0
    s_cbranch_scc1 B_ek
    s_lshl_b32 s8, s3, 11
    s_add_u32 s8, s8, 65536
    v_add_u32 v6, s8, v2
    s_mov_b32 s8, 0x3e8b97f6
    s_nop 5
    v_pk_mul_f32 v[16:17], v[16:17], s[8:9] op_sel_hi:[1,0]
    v_pk_mul_f32 v[18:19], v[18:19], s[8:9] op_sel_hi:[1,0]
    v_pk_mul_f32 v[20:21], v[20:21], s[8:9] op_sel_hi:[1,0]
    v_pk_mul_f32 v[22:23], v[22:23], s[8:9] op_sel_hi:[1,0]
    v_pk_mul_f32 v[24:25], v[24:25], s[8:9] op_sel_hi:[1,0]
    v_pk_mul_f32 v[26:27], v[26:27], s[8:9] op_sel_hi:[1,0]
    v_pk_mul_f32 v[28:29], v[28:29], s[8:9] op_sel_hi:[1,0]
    v_pk_mul_f32 v[30:31], v[30:31], s[8:9] op_sel_hi:[1,0]
    v_cvt_pk_bf16_f32 v8, v16, v17
    v_cvt_pk_bf16_f32 v9, v18, v19
    v_cvt_pk_bf16_f32 v10, v20, v21
    v_cvt_pk_bf16_f32 v11, v22, v23
    v_cvt_pk_bf16_f32 v12, v24, v25
    v_cvt_pk_bf16_f32 v13, v26, v27
    v_cvt_pk_bf16_f32 v14, v28, v29
    v_cvt_pk_bf16_f32 v15, v30, v31
    s_mov_b32 exec_lo, 0
    v_mov_b32 v14, 0
    v_mov_b32 v15, 0
    s_mov_b32 exec_lo, -1
    ds_write_b128 v6, v[8:11]
    ds_write_b128 v6, v[12:15] offset:1024
B_qdone:
    s_and_b32 s10, s3, 3
    s_lshr_b32 s11, s3, 2
    s_lshl_b32 s8, s11, 15
    v_add_u32 v4, s8, v2
    s_lshl_b32 s8, s3, 2
    s_add_u32 s8, s8, 81856
    v_mov_b32 v96, s8
    s_xor_b32 s8, s8, 16
    v_mov_b32 v97, s8
    s_lshl_b32 s8, s11, 2
    s_add_u32 s8, s8, 81888
    s_mov_b32 exec_hi, 0
    v_mov_b32 v97, s8
    s_mov_b32 exec_hi, -1
    s_waitcnt lgkmcnt(0)
    s_barrier
    buffer_load_dwordx2 v[124:125], v127, s[68:71], 0 offen sc1
    s_cmp_eq_u32 s11, 0
    s_cbranch_scc1 B_start
    s_lshl_b32 s8, s10, 11
    s_add_u32 s8, s8, 65536
    v_add_u32 v6, s8, v2
    ds_read_b128 v[8:11], v6
    ds_read_b128 v[12:15], v6 offset:1024
B_start:
    ds_write_b32 v96, v127
    v_pk_mul_f32 v[16:17], v[126:127], 0 op_sel:[1,0]
    v_pk_mul_f32 v[18:19], v[126:127], 0 op_sel:[1,0]
    v_pk_mul_f32 v[20:21], v[126:127], 0 op_sel:[1,0]
    v_pk_mul_f32 v[22:23], v[126:127], 0 op_sel:[1,0]
    v_pk_mul_f32 v[24:25], v[126:127], 0 op_sel:[1,0]
    v_pk_mul_f32 v[26:27], v[126:127], 0 op_sel:[1,0]
    v_pk_mul_f32 v[28:29], v[126:127], 0 op_sel:[1,0]
    v_pk_mul_f32 v[30:31], v[126:127], 0 op_sel:[1,0]
    v_mov_b32 v68, 0
    v_mov_b32 v84, 0
    v_mov_b32 v69, 0
    v_mov_b32 v85, 0
    v_mov_b32 v70, 0
    v_mov_b32 v86, 0
    v_mov_b32 v71, 0
    v_mov_b32 v87, 0
    s_waitcnt lgkmcnt(0)
    s_barrier
    ds_read_b128 v[72:75], v4 offset:0
    ds_read_b128 v[76:79], v4 offset:1024
    s_waitcnt lgkmcnt(0)
    v_mfma_f32_32x32x16_bf16 v[32:47], v[72:75], v[8:11], 0
    v_mfma_f32_32x32x16_bf16 v[32:47], v[76:79], v[12:15], v[32:47]
    ds_read_b128 v[72:75], v4 offset:2048
    ds_read_b128 v[76:79], v4 offset:3072
    ds_read_b128 v[80:83], v4 offset:7168
    s_mov_b32 s13, 4
    v_mov_b32 v98, 1
    s_waitcnt lgkmcnt(0)
    s_nop 4
    s_barrier
.p2align 6
B_loop:
    v_mfma_f32_32x32x16_bf16 v[48:63], v[72:75], v[8:11], 0
    ds_read_b128 v[72:75], v4 offset:8192
    v_exp_f32 v32, v32
    v_exp_f32 v33, v33
    v_exp_f32 v34, v34
    v_exp_f32 v35, v35
    v_cvt_pk_bf16_f32 v64, v32, v33
    v_cvt_pk_bf16_f32 v65, v34, v35
    v_mfma_f32_32x32x16_bf16 v[16:31], v[84:87], v[68:71], v[16:31]
    ds_read_b128 v[84:87], v4 offset:14336
    v_exp_f32 v36, v36
    v_exp_f32 v37, v37
    v_exp_f32 v38, v38
    v_exp_f32 v39, v39
    v_cvt_pk_bf16_f32 v66, v36, v37
    v_cvt_pk_bf16_f32 v67, v38, v39
    s_waitcnt lgkmcnt(2)
    ds_write_b32 v96, v98
    v_mfma_f32_32x32x16_bf16 v[48:63], v[76:79], v[12:15], v[48:63]
    ds_read_b128 v[76:79], v4 offset:9216
    v_exp_f32 v40, v40
    v_exp_f32 v41, v41
    v_exp_f32 v42, v42
    v_exp_f32 v43, v43
    v_cvt_pk_bf16_f32 v68, v40, v41
    v_cvt_pk_bf16_f32 v69, v42, v43
    v_mfma_f32_32x32x16_bf16 v[16:31], v[80:83], v[64:67], v[16:31]
    ds_read_b128 v[80:83], v4 offset:12288
    v_exp_f32 v44, v44
    v_exp_f32 v45, v45
    v_exp_f32 v46, v46
    v_exp_f32 v47, v47
    v_cvt_pk_bf16_f32 v70, v44, v45
    v_cvt_pk_bf16_f32 v71, v46, v47
    s_waitcnt lgkmcnt(3)
    v_mfma_f32_32x32x16_bf16 v[32:47], v[72:75], v[8:11], 0
    ds_read_b128 v[72:75], v4 offset:10240
    v_exp_f32 v48, v48
    v_exp_f32 v49, v49
    v_exp_f32 v50, v50
    v_exp_f32 v51, v51
    v_cvt_pk_bf16_f32 v64, v48, v49
    v_cvt_pk_bf16_f32 v65, v50, v51
    v_mfma_f32_32x32x16_bf16 v[16:31], v[84:87], v[68:71], v[16:31]
    ds_read_b128 v[84:87], v4 offset:13312
    ds_read_b32 v99, v97
    v_exp_f32 v52, v52
    v_exp_f32 v53, v53
    v_exp_f32 v54, v54
    v_exp_f32 v55, v55
    v_cvt_pk_bf16_f32 v66, v52, v53
    v_cvt_pk_bf16_f32 v67, v54, v55
    s_waitcnt lgkmcnt(3)
    v_mfma_f32_32x32x16_bf16 v[32:47], v[76:79], v[12:15], v[32:47]
    ds_read_b128 v[76:79], v4 offset:11264
    v_exp_f32 v56, v56
    v_exp_f32 v57, v57
    v_exp_f32 v58, v58
    v_exp_f32 v59, v59
    v_cvt_pk_bf16_f32 v68, v56, v57
    v_cvt_pk_bf16_f32 v69, v58, v59
    s_waitcnt lgkmcnt(1)
    v_cmp_gt_u32 vcc, v98, v99
    v_mfma_f32_32x32x16_bf16 v[16:31], v[80:83], v[64:67], v[16:31]
    s_setprio 2
    s_cbranch_vccnz pg_3
pg_1:
    ds_read_b128 v[80:83], v4 offset:15360
    v_add_u32 v98, 1, v98
    v_exp_f32 v60, v60
    v_exp_f32 v61, v61
    v_exp_f32 v62, v62
    v_exp_f32 v63, v63
    v_cvt_pk_bf16_f32 v70, v60, v61
    v_cvt_pk_bf16_f32 v71, v62, v63
    v_mfma_f32_32x32x16_bf16 v[48:63], v[72:75], v[8:11], 0
    ds_read_b128 v[72:75], v4 offset:16384
    v_exp_f32 v32, v32
    v_exp_f32 v33, v33
    v_exp_f32 v34, v34
    v_exp_f32 v35, v35
    v_cvt_pk_bf16_f32 v64, v32, v33
    v_cvt_pk_bf16_f32 v65, v34, v35
    v_mfma_f32_32x32x16_bf16 v[16:31], v[84:87], v[68:71], v[16:31]
    ds_read_b128 v[84:87], v4 offset:22528
    v_exp_f32 v36, v36
    v_exp_f32 v37, v37
    v_exp_f32 v38, v38
    v_exp_f32 v39, v39
    v_cvt_pk_bf16_f32 v66, v36, v37
    v_cvt_pk_bf16_f32 v67, v38, v39
    s_waitcnt lgkmcnt(2)
    ds_write_b32 v96, v98
    v_mfma_f32_32x32x16_bf16 v[48:63], v[76:79], v[12:15], v[48:63]
    ds_read_b128 v[76:79], v4 offset:17408
    v_exp_f32 v40, v40
    v_exp_f32 v41, v41
    v_exp_f32 v42, v42
    v_exp_f32 v43, v43
    v_cvt_pk_bf16_f32 v68, v40, v41
    v_cvt_pk_bf16_f32 v69, v42, v43
    v_mfma_f32_32x32x16_bf16 v[16:31], v[80:83], v[64:67], v[16:31]
    ds_read_b128 v[80:83], v4 offset:20480
    v_exp_f32 v44, v44
    v_exp_f32 v45, v45
    v_exp_f32 v46, v46
    v_exp_f32 v47, v47
    v_cvt_pk_bf16_f32 v70, v44, v45
    v_cvt_pk_bf16_f32 v71, v46, v47
    s_waitcnt lgkmcnt(3)
    v_mfma_f32_32x32x16_bf16 v[32:47], v[72:75], v[8:11], 0
    ds_read_b128 v[72:75], v4 offset:18432
    v_exp_f32 v48, v48
    v_exp_f32 v49, v49
    v_exp_f32 v50, v50
    v_exp_f32 v51, v51
    v_cvt_pk_bf16_f32 v64, v48, v49
    v_cvt_pk_bf16_f32 v65, v50, v51
    v_mfma_f32_32x32x16_bf16 v[16:31], v[84:87], v[68:71], v[16:31]
    ds_read_b128 v[84:87], v4 offset:21504
    ds_read_b32 v99, v97
    v_exp_f32 v52, v52
    v_exp_f32 v53, v53
    v_exp_f32 v54, v54
    v_exp_f32 v55, v55
    v_cvt_pk_bf16_f32 v66, v52, v53
    v_cvt_pk_bf16_f32 v67, v54, v55
    s_waitcnt lgkmcnt(3)
    v_mfma_f32_32x32x16_bf16 v[32:47], v[76:79], v[12:15], v[32:47]
    ds_read_b128 v[76:79], v4 offset:19456
    v_exp_f32 v56, v56
    v_exp_f32 v57, v57
    v_exp_f32 v58, v58
    v_exp_f32 v59, v59
    v_cvt_pk_bf16_f32 v68, v56, v57
    v_cvt_pk_bf16_f32 v69, v58, v59
    s_waitcnt lgkmcnt(1)
    v_cmp_gt_u32 vcc, v98, v99
    v_mfma_f32_32x32x16_bf16 v[16:31], v[80:83], v[64:67], v[16:31]
    s_setprio 2
    s_cbranch_vccnz pg_6
pg_4:
    ds_read_b128 v[80:83], v4 offset:23552
    v_add_u32 v98, 1, v98
    v_exp_f32 v60, v60
    v_exp_f32 v61, v61
    v_exp_f32 v62, v62
    v_exp_f32 v63, v63
    v_cvt_pk_bf16_f32 v70, v60, v61
    v_cvt_pk_bf16_f32 v71, v62, v63
    v_mfma_f32_32x32x16_bf16 v[48:63], v[72:75], v[8:11], 0
    ds_read_b128 v[72:75], v4 offset:24576
    v_exp_f32 v32, v32
    v_exp_f32 v33, v33
    v_exp_f32 v34, v34
    v_exp_f32 v35, v35
    v_cvt_pk_bf16_f32 v64, v32, v33
    v_cvt_pk_bf16_f32 v65, v34, v35
    v_mfma_f32_32x32x16_bf16 v[16:31], v[84:87], v[68:71], v[16:31]
    ds_read_b128 v[84:87], v4 offset:30720
    v_exp_f32 v36, v36
    v_exp_f32 v37, v37
    v_exp_f32 v38, v38
    v_exp_f32 v39, v39
    v_cvt_pk_bf16_f32 v66, v36, v37
    v_cvt_pk_bf16_f32 v67, v38, v39
    s_waitcnt lgkmcnt(2)
    ds_write_b32 v96, v98
    v_mfma_f32_32x32x16_bf16 v[48:63], v[76:79], v[12:15], v[48:63]
    ds_read_b128 v[76:79], v4 offset:25600
    v_exp_f32 v40, v40
    v_exp_f32 v41, v41
    v_exp_f32 v42, v42
    v_exp_f32 v43, v43
    v_cvt_pk_bf16_f32 v68, v40, v41
    v_cvt_pk_bf16_f32 v69, v42, v43
    v_mfma_f32_32x32x16_bf16 v[16:31], v[80:83], v[64:67], v[16:31]
    ds_read_b128 v[80:83], v4 offset:28672
    v_exp_f32 v44, v44
    v_exp_f32 v45, v45
    v_exp_f32 v46, v46
    v_exp_f32 v47, v47
    v_cvt_pk_bf16_f32 v70, v44, v45
    v_cvt_pk_bf16_f32 v71, v46, v47
    s_waitcnt lgkmcnt(3)
    v_mfma_f32_32x32x16_bf16 v[32:47], v[72:75], v[8:11], 0
    ds_read_b128 v[72:75], v4 offset:26624
    v_exp_f32 v48, v48
    v_exp_f32 v49, v49
    v_exp_f32 v50, v50
    v_exp_f32 v51, v51
    v_cvt_pk_bf16_f32 v64, v48, v49
    v_cvt_pk_bf16_f32 v65, v50, v51
    v_mfma_f32_32x32x16_bf16 v[16:31], v[84:87], v[68:71], v[16:31]
    ds_read_b128 v[84:87], v4 offset:29696
    ds_read_b32 v99, v97
    v_exp_f32 v52, v52
    v_exp_f32 v53, v53
    v_exp_f32 v54, v54
    v_exp_f32 v55, v55
    v_cvt_pk_bf16_f32 v66, v52, v53
    v_cvt_pk_bf16_f32 v67, v54, v55
    s_waitcnt lgkmcnt(3)
    v_mfma_f32_32x32x16_bf16 v[32:47], v[76:79], v[12:15], v[32:47]
    ds_read_b128 v[76:79], v4 offset:27648
    v_exp_f32 v56, v56
    v_exp_f32 v57, v57
    v_exp_f32 v58, v58
    v_exp_f32 v59, v59
    v_cvt_pk_bf16_f32 v68, v56, v57
    v_cvt_pk_bf16_f32 v69, v58, v59
    s_waitcnt lgkmcnt(1)
    v_cmp_gt_u32 vcc, v98, v99
    v_mfma_f32_32x32x16_bf16 v[16:31], v[80:83], v[64:67], v[16:31]
    s_setprio 2
    s_cbranch_vccnz pg_9
pg_7:
    ds_read_b128 v[80:83], v4 offset:31744
    v_add_u32 v98, 1, v98
    v_exp_f32 v60, v60
    v_exp_f32 v61, v61
    v_exp_f32 v62, v62
    v_exp_f32 v63, v63
    v_cvt_pk_bf16_f32 v70, v60, v61
    v_cvt_pk_bf16_f32 v71, v62, v63
    v_mfma_f32_32x32x16_bf16 v[48:63], v[72:75], v[8:11], 0
    ds_read_b128 v[72:75], v4 offset:0
    v_exp_f32 v32, v32
    v_exp_f32 v33, v33
    v_exp_f32 v34, v34
    v_exp_f32 v35, v35
    v_cvt_pk_bf16_f32 v64, v32, v33
    v_cvt_pk_bf16_f32 v65, v34, v35
    v_mfma_f32_32x32x16_bf16 v[16:31], v[84:87], v[68:71], v[16:31]
    ds_read_b128 v[84:87], v4 offset:6144
    v_exp_f32 v36, v36
    v_exp_f32 v37, v37
    v_exp_f32 v38, v38
    v_exp_f32 v39, v39
    v_cvt_pk_bf16_f32 v66, v36, v37
    v_cvt_pk_bf16_f32 v67, v38, v39
    s_waitcnt lgkmcnt(2)
    ds_write_b32 v96, v98
    v_mfma_f32_32x32x16_bf16 v[48:63], v[76:79], v[12:15], v[48:63]
    ds_read_b128 v[76:79], v4 offset:1024
    v_exp_f32 v40, v40
    v_exp_f32 v41, v41
    v_exp_f32 v42, v42
    v_exp_f32 v43, v43
    v_cvt_pk_bf16_f32 v68, v40, v41
    v_cvt_pk_bf16_f32 v69, v42, v43
    v_mfma_f32_32x32x16_bf16 v[16:31], v[80:83], v[64:67], v[16:31]
    ds_read_b128 v[80:83], v4 offset:4096
    v_exp_f32 v44, v44
    v_exp_f32 v45, v45
    v_exp_f32 v46, v46
    v_exp_f32 v47, v47
    v_cvt_pk_bf16_f32 v70, v44, v45
    v_cvt_pk_bf16_f32 v71, v46, v47
    s_waitcnt lgkmcnt(3)
    v_mfma_f32_32x32x16_bf16 v[32:47], v[72:75], v[8:11], 0
    ds_read_b128 v[72:75], v4 offset:2048
    v_exp_f32 v48, v48
    v_exp_f32 v49, v49
    v_exp_f32 v50, v50
    v_exp_f32 v51, v51
    v_cvt_pk_bf16_f32 v64, v48, v49
    v_cvt_pk_bf16_f32 v65, v50, v51
    v_mfma_f32_32x32x16_bf16 v[16:31], v[84:87], v[68:71], v[16:31]
    ds_read_b128 v[84:87], v4 offset:5120
    ds_read_b32 v99, v97
    v_exp_f32 v52, v52
    v_exp_f32 v53, v53
    v_exp_f32 v54, v54
    v_exp_f32 v55, v55
    v_cvt_pk_bf16_f32 v66, v52, v53
    v_cvt_pk_bf16_f32 v67, v54, v55
    s_waitcnt lgkmcnt(3)
    v_mfma_f32_32x32x16_bf16 v[32:47], v[76:79], v[12:15], v[32:47]
    ds_read_b128 v[76:79], v4 offset:3072
    v_exp_f32 v56, v56
    v_exp_f32 v57, v57
    v_exp_f32 v58, v58
    v_exp_f32 v59, v59
    v_cvt_pk_bf16_f32 v68, v56, v57
    v_cvt_pk_bf16_f32 v69, v58, v59
    s_waitcnt lgkmcnt(1)
    v_cmp_gt_u32 vcc, v98, v99
    v_mfma_f32_32x32x16_bf16 v[16:31], v[80:83], v[64:67], v[16:31]
    s_setprio 2
    s_cbranch_vccnz pg_12
pg_10:
    ds_read_b128 v[80:83], v4 offset:7168
    v_add_u32 v98, 1, v98
    v_exp_f32 v60, v60
    v_exp_f32 v61, v61
    v_exp_f32 v62, v62
    v_exp_f32 v63, v63
    v_cvt_pk_bf16_f32 v70, v60, v61
    v_cvt_pk_bf16_f32 v71, v62, v63
    s_sub_u32 s13, s13, 1
    s_cmp_lg_u32 s13, 0
    s_cbranch_scc1 B_loop
    s_setprio 3
    s_waitcnt lgkmcnt(0)
    v_mfma_f32_32x32x16_bf16 v[16:31], v[84:87], v[68:71], v[16:31]
    s_lshl_b32 s8, s10, 12
    s_add_u32 s8, s8, 64512
    v_add_u32 v6, s8, v2
    s_cmp_eq_u32 s11, 0
    s_cbranch_scc1 B_lo
    v_and_b32 v7, 3, v1
    v_lshlrev_b32 v7, 2, v7
    v_add_u32 v7, 81872, v7
    s_cmp_lg_u32 s10, 0
    s_cbranch_scc1 B_hiw
B_hisp:
    ds_read_b32 v99, v7
    s_waitcnt lgkmcnt(0)
    v_cmp_gt_u32 vcc, 16, v99
    s_cbranch_vccnz B_hisp
B_hiw:
    s_nop 3
    ds_write_b128 v6, v[16:19] offset:0
    ds_write_b128 v6, v[20:23] offset:1024
    ds_write_b128 v6, v[24:27] offset:2048
    ds_write_b128 v6, v[28:31] offset:3072
    s_waitcnt lgkmcnt(0)
    s_barrier
    s_branch B_chk
B_lo:
    s_lshr_b32 s8, s10, 1
    s_lshl_b32 s14, s7, 1
    s_add_u32 s8, s8, s14
    s_mul_i32 s8, s8, 7
    v_lshrrev_b32 v90, 5, v1
    v_add_u32 v90, s8, v90
    v_and_b32 v91, 31, v1
    v_lshlrev_b32 v91, 4, v91
    v_lshrrev_b32 v93, 1, v90
    v_lshl_add_u32 v93, v93, 9, v91
    v_and_b32 v92, 1, v90
    v_lshl_add_u32 v93, v92, 3, v93
    s_lshl_b32 s14, s6, 1
    s_and_b32 s8, s10, 1
    s_add_u32 s14, s14, s8
    s_mul_i32 s14, s14, 28672
    s_add_u32 s14, s14, 786432
    v_mov_b32 v90, 0x5f800000
    s_lshl_b32 s12, s6, 5
    s_lshl_b32 s8, s7, 2
    s_add_u32 s8, s8, s10
    s_add_u32 s12, s12, s8
    s_lshl_b32 s12, s12, 7
    s_add_u32 s12, s12, 589824
    v_mov_b32 v94, 0
    v_mov_b32 v95, 0
    v_mov_b32 v91, 81896
    s_barrier
    ds_read_b32 v91, v91
    ds_read_b128 v[32:35], v6 offset:0
    ds_read_b128 v[36:39], v6 offset:1024
    ds_read_b128 v[40:43], v6 offset:2048
    ds_read_b128 v[44:47], v6 offset:3072
    s_waitcnt lgkmcnt(0)
    v_readfirstlane_b32 s50, v91
    v_pk_add_f32 v[28:29], v[28:29], v[44:45]
    v_mov_b32 v88, v28
    v_mov_b32 v7, v28
    v_pk_add_f32 v[16:17], v[16:17], v[32:33]
    v_pk_add_f32 v[18:19], v[18:19], v[34:35]
    v_pk_add_f32 v[20:21], v[20:21], v[36:37]
    v_pk_add_f32 v[22:23], v[22:23], v[38:39]
    v_pk_add_f32 v[24:25], v[24:25], v[40:41]
    v_pk_add_f32 v[26:27], v[26:27], v[42:43]
    v_pk_add_f32 v[30:31], v[30:31], v[46:47]
    v_permlane32_swap_b32 v88, v7
    s_nop 0
    v_rcp_f32 v88, v7
    v_cmp_gt_f32 vcc, 0x2f800000, v7
    v_cmp_nle_f32 s[60:61], v7, v90
    v_pk_mul_f32 v[16:17], v[16:17], v[88:89] op_sel_hi:[1,0]
    v_pk_mul_f32 v[18:19], v[18:19], v[88:89] op_sel_hi:[1,0]
    v_pk_mul_f32 v[20:21], v[20:21], v[88:89] op_sel_hi:[1,0]
    v_pk_mul_f32 v[22:23], v[22:23], v[88:89] op_sel_hi:[1,0]
    v_pk_mul_f32 v[24:25], v[24:25], v[88:89] op_sel_hi:[1,0]
    v_pk_mul_f32 v[26:27], v[26:27], v[88:89] op_sel_hi:[1,0]
    v_pk_mul_f32 v[28:29], v[28:29], v[88:89] op_sel_hi:[1,0]
    v_pk_mul_f32 v[30:31], v[30:31], v[88:89] op_sel_hi:[1,0]
    v_cvt_pk_bf16_f32 v64, v16, v17
    v_cvt_pk_bf16_f32 v65, v18, v19
    v_cvt_pk_bf16_f32 v66, v20, v21
    v_cvt_pk_bf16_f32 v67, v22, v23
    v_cvt_pk_bf16_f32 v68, v24, v25
    v_cvt_pk_bf16_f32 v69, v26, v27
    v_cvt_pk_bf16_f32 v70, v28, v29
    v_cvt_pk_bf16_f32 v71, v30, v31
    s_or_b64 s[60:61], vcc, s[60:61]
    s_cmp_lg_u32 s50, 1
    s_cbranch_scc1 B_ost_g
    buffer_store_dwordx2 v[64:65], v93, s[64:67], s14 offen offset:0
    buffer_store_dwordx2 v[66:67], v93, s[64:67], s14 offen offset:512
    buffer_store_dwordx2 v[68:69], v93, s[64:67], s14 offen offset:1024
    s_mov_b32 exec_hi, 0
    buffer_store_dwordx2 v[70:71], v93, s[64:67], s14 offen offset:1536
    s_mov_b32 exec_hi, -1
B_ost_d:
    v_pk_fma_f32 v[94:95], v[16:17], 0, v[94:95]
    v_pk_fma_f32 v[94:95], v[18:19], 0, v[94:95]
    v_pk_fma_f32 v[94:95], v[20:21], 0, v[94:95]
    v_pk_fma_f32 v[94:95], v[22:23], 0, v[94:95]
    v_pk_fma_f32 v[94:95], v[24:25], 0, v[94:95]
    v_pk_fma_f32 v[94:95], v[26:27], 0, v[94:95]
    v_pk_fma_f32 v[94:95], v[28:29], 0, v[94:95]
    v_pk_fma_f32 v[94:95], v[30:31], 0, v[94:95]
    v_cmp_u_f32 vcc, v94, v95
    s_or_b64 vcc, vcc, s[60:61]
    s_cselect_b32 s8, 1, 0
    s_andn2_b32 s8, s8, s63
    v_mov_b32 v7, s8
    ds_write_b32 v96, v7
    s_cmp_lg_u32 s8, 0
    s_cbranch_scc1 B_chk
    s_mov_b64 exec, 1
    s_waitcnt vmcnt(0)
    s_cmp_lg_u32 s50, 1
    s_cbranch_scc1 B_fl_g
    buffer_store_dwordx2 v[124:125], v127, s[64:67], s12 offen
B_fl_d:
    s_mov_b64 exec, -1
B_chk:
    v_and_b32 v7, 3, v1
    v_lshlrev_b32 v7, 2, v7
    v_add_u32 v7, 81856, v7
    s_waitcnt lgkmcnt(0)
    s_barrier
    ds_read_b32 v7, v7
    s_lshr_b32 s13, s3, 1
    s_mul_i32 s8, s13, 14336
    v_bfe_u32 v98, v1, 4, 1
    v_lshlrev_b32 v99, 5, v98
    v_and_b32 v98, 3, v1
    v_lshl_add_u32 v99, v98, 3, v99
    v_lshrrev_b32 v98, 5, v1
    v_lshl_add_u32 v99, v98, 10, v99
    v_bfe_u32 v98, v1, 2, 2
    v_lshl_add_u32 v99, v98, 7, v99
    v_bfe_u32 v98, v1, 3, 1
    v_lshl_add_u32 v99, v98, 6, v99
    v_add_u32 v99, s8, v99
    s_waitcnt lgkmcnt(0)
    v_cmp_ne_u32 vcc, 0, v7
    s_cbranch_vccnz B_slow
    s_cmp_eq_u32 s7, 7
    s_cbranch_scc1 L_fin
    v_mov_b32 v4, v99
    v_xor_b32 v3, 64, v99
    s_and_b32 s10, s3, 1
    s_lshr_b32 s11, s3, 1
    s_lshl_b32 s14, s6, 5
    s_lshl_b32 s8, s11, 3
    s_add_u32 s14, s14, s8
    s_add_u32 s14, s14, s10
    s_lshl_b32 s14, s14, 7
    s_add_u32 s14, s14, 589824
    v_lshlrev_b32 v5, 8, v1
    s_mov_b64 exec, 15
    buffer_load_dwordx2 v[6:7], v5, s[64:67], s14 offen sc1
    s_mov_b64 exec, -1
    ds_read_b64_tr_b16 v[8:9], v4 offset:0
    ds_read_b64_tr_b16 v[10:11], v4 offset:512
    ds_read_b64_tr_b16 v[12:13], v3 offset:0
    ds_read_b64_tr_b16 v[14:15], v3 offset:512
    ds_read_b64_tr_b16 v[16:17], v4 offset:2048
    ds_read_b64_tr_b16 v[18:19], v4 offset:2560
    ds_read_b64_tr_b16 v[20:21], v3 offset:2048
    ds_read_b64_tr_b16 v[22:23], v3 offset:2560
    ds_read_b64_tr_b16 v[24:25], v4 offset:4096
    ds_read_b64_tr_b16 v[26:27], v4 offset:4608
    ds_read_b64_tr_b16 v[28:29], v3 offset:4096
    ds_read_b64_tr_b16 v[30:31], v3 offset:4608
    s_waitcnt lgkmcnt(0)
    ds_read_b64_tr_b16 v[32:33], v4 offset:6144
    ds_read_b64_tr_b16 v[34:35], v4 offset:6656
    ds_read_b64_tr_b16 v[36:37], v3 offset:6144
    ds_read_b64_tr_b16 v[38:39], v3 offset:6656
    ds_read_b64_tr_b16 v[40:41], v4 offset:8192
    ds_read_b64_tr_b16 v[42:43], v4 offset:8704
    ds_read_b64_tr_b16 v[44:45], v3 offset:8192
    ds_read_b64_tr_b16 v[46:47], v3 offset:8704
    ds_read_b64_tr_b16 v[48:49], v4 offset:10240
    ds_read_b64_tr_b16 v[50:51], v4 offset:10752
    ds_read_b64_tr_b16 v[52:53], v3 offset:10240
    ds_read_b64_tr_b16 v[54:55], v3 offset:10752
    s_waitcnt lgkmcnt(0)
    ds_read_b64_tr_b16 v[56:57], v4 offset:12288
    ds_read_b64_tr_b16 v[58:59], v4 offset:12800
    ds_read_b64_tr_b16 v[60:61], v3 offset:12288
    ds_read_b64_tr_b16 v[62:63], v3 offset:12800
    s_mov_b32 s76, s44
    s_mov_b32 s77, s45
    s_mov_b32 s78, 0x700000
    s_mov_b32 s79, 0x00020000
    s_lshl_b32 s8, s6, 1
    s_add_u32 s8, s8, s10
    s_mul_i32 s12, s8, 28672
    s_mul_i32 s60, s8, 114688
    s_mul_i32 s8, s11, 7168
    s_add_u32 s12, s12, s8
    s_add_u32 s12, s12, 786432
    s_add_u32 s13, s12, 4096
    s_waitcnt lgkmcnt(0)
    s_barrier
    s_mov_b64 exec, 15
    s_waitcnt vmcnt(0)
    v_cmp_ne_u64 vcc, v[6:7], v[124:125]
    s_mov_b64 exec, -1
    s_cbranch_vccz B_ow
    s_mov_b32 s100, 0
    s_mov_b32 exec_lo, 15
    s_mov_b32 exec_hi, 0
fp_13:
    buffer_load_dwordx2 v[6:7], v5, s[64:67], s14 offen sc1
    s_waitcnt vmcnt(0)
    v_cmp_ne_u64 vcc, v[6:7], v[124:125]
    s_cbranch_vccz fp_14
    s_add_u32 s100, s100, 1
    s_cmp_lt_u32 s100, 2097152
    s_cbranch_scc1 fp_13
fp_14:
    s_mov_b64 exec, -1
B_ow:
    buffer_load_dwordx4 v[64:67], v2, s[64:67], s12 offen offset:0 sc1
    buffer_load_dwordx4 v[68:71], v2, s[64:67], s12 offen offset:1024 sc1
    buffer_load_dwordx4 v[72:75], v2, s[64:67], s12 offen offset:2048 sc1
    buffer_load_dwordx4 v[76:79], v2, s[64:67], s12 offen offset:3072 sc1
    buffer_load_dwordx4 v[80:83], v2, s[64:67], s13 offen offset:0 sc1
    buffer_load_dwordx4 v[84:87], v2, s[64:67], s13 offen offset:1024 sc1
    buffer_load_dwordx4 v[88:91], v2, s[64:67], s13 offen offset:2048 sc1
    s_lshl_b32 s8, s10, 15
    s_lshl_b32 s12, s11, 11
    s_add_u32 s12, s12, s8
    v_add_u32 v4, s12, v2
    s_lshl_b32 s12, s11, 13
    s_add_u32 s12, s12, s8
    v_add_u32 v5, s12, v2
    v_lshrrev_b32 v6, 5, v1
    v_mul_u32_u24 v6, 14336, v6
    v_and_b32 v7, 31, v1
    v_lshl_add_u32 v6, v7, 2, v6
    s_lshl_b32 s8, s7, 1
    s_lshr_b32 s12, s11, 1
    s_add_u32 s8, s8, s12
    s_lshl_b32 s8, s8, 7
    s_add_u32 s60, s60, s8
    s_and_b32 s8, s11, 1
    s_mul_i32 s8, s8, 57344
    s_add_u32 s60, s60, s8
    s_waitcnt vmcnt(6)
    v_mfma_f32_32x32x16_bf16 v[92:107], v[64:67], v[8:11], 0
    v_mfma_f32_32x32x16_bf16 v[108:123], v[64:67], v[12:15], 0
    s_waitcnt vmcnt(5)
    v_mfma_f32_32x32x16_bf16 v[92:107], v[68:71], v[16:19], v[92:107]
    v_mfma_f32_32x32x16_bf16 v[108:123], v[68:71], v[20:23], v[108:123]
    s_waitcnt vmcnt(4)
    v_mfma_f32_32x32x16_bf16 v[92:107], v[72:75], v[24:27], v[92:107]
    v_mfma_f32_32x32x16_bf16 v[108:123], v[72:75], v[28:31], v[108:123]
    s_waitcnt vmcnt(3)
    v_mfma_f32_32x32x16_bf16 v[92:107], v[76:79], v[32:35], v[92:107]
    v_mfma_f32_32x32x16_bf16 v[108:123], v[76:79], v[36:39], v[108:123]
    s_waitcnt vmcnt(2)
    v_mfma_f32_32x32x16_bf16 v[92:107], v[80:83], v[40:43], v[92:107]
    v_mfma_f32_32x32x16_bf16 v[108:123], v[80:83], v[44:47], v[108:123]
    s_waitcnt vmcnt(1)
    v_mfma_f32_32x32x16_bf16 v[92:107], v[84:87], v[48:51], v[92:107]
    v_mfma_f32_32x32x16_bf16 v[108:123], v[84:87], v[52:55], v[108:123]
    s_waitcnt vmcnt(0)
    v_mfma_f32_32x32x16_bf16 v[92:107], v[88:91], v[56:59], v[92:107]
    v_mfma_f32_32x32x16_bf16 v[108:123], v[88:91], v[60:63], v[108:123]
    s_nop 11
    ds_write_b128 v4, v[92:95] offset:0
    ds_write_b128 v4, v[96:99] offset:1024
    ds_write_b128 v4, v[100:103] offset:8192
    ds_write_b128 v4, v[104:107] offset:9216
    ds_write_b128 v4, v[108:111] offset:16384
    ds_write_b128 v4, v[112:115] offset:17408
    ds_write_b128 v4, v[116:119] offset:24576
    ds_write_b128 v4, v[120:123] offset:25600
    s_waitcnt lgkmcnt(0)
    s_barrier
    ds_read_b128 v[8:11], v5 offset:0
    ds_read_b128 v[12:15], v5 offset:1024
    ds_read_b128 v[16:19], v5 offset:2048
    ds_read_b128 v[20:23], v5 offset:3072
    ds_read_b128 v[24:27], v5 offset:4096
    ds_read_b128 v[28:31], v5 offset:5120
    ds_read_b128 v[32:35], v5 offset:6144
    ds_read_b128 v[36:39], v5 offset:7168
    s_waitcnt lgkmcnt(4)
    v_pk_add_f32 v[8:9], v[8:9], v[16:17]
    v_pk_add_f32 v[10:11], v[10:11], v[18:19]
    v_pk_add_f32 v[12:13], v[12:13], v[20:21]
    v_pk_add_f32 v[14:15], v[14:15], v[22:23]
    s_waitcnt lgkmcnt(0)
    v_pk_add_f32 v[24:25], v[24:25], v[32:33]
    v_pk_add_f32 v[26:27], v[26:27], v[34:35]
    v_pk_add_f32 v[28:29], v[28:29], v[36:37]
    v_pk_add_f32 v[30:31], v[30:31], v[38:39]
    v_pk_add_f32 v[8:9], v[8:9], v[24:25]
    v_pk_add_f32 v[10:11], v[10:11], v[26:27]
    v_pk_add_f32 v[12:13], v[12:13], v[28:29]
    v_pk_add_f32 v[14:15], v[14:15], v[30:31]
    s_add_u32 s14, s60, 1792
    buffer_store_dword v8, v6, s[76:79], s14 offen nt
    s_add_u32 s14, s60, 5376
    buffer_store_dword v9, v6, s[76:79], s14 offen nt
    s_add_u32 s14, s60, 8960
    buffer_store_dword v10, v6, s[76:79], s14 offen nt
    s_add_u32 s14, s60, 12544
    buffer_store_dword v11, v6, s[76:79], s14 offen nt
    s_add_u32 s14, s60, 30464
    buffer_store_dword v12, v6, s[76:79], s14 offen nt
    s_add_u32 s14, s60, 34048
    buffer_store_dword v13, v6, s[76:79], s14 offen nt
    s_add_u32 s14, s60, 37632
    buffer_store_dword v14, v6, s[76:79], s14 offen nt
    s_add_u32 s14, s60, 41216
    buffer_store_dword v15, v6, s[76:79], s14 offen nt
    s_endpgm
pg_3:
    s_cmp_lg_u32 vcc_lo, 0
    s_cbranch_scc1 pg_2
    s_setprio 1
    s_branch pg_1
pg_2:
    ds_read_b32 v99, v97
    s_waitcnt lgkmcnt(0)
    v_cmp_gt_u32 vcc, v98, v99
    s_cmp_lg_u32 vcc_lo, 0
    s_cbranch_scc1 pg_2
    s_branch pg_1
pg_6:
    s_cmp_lg_u32 vcc_lo, 0
    s_cbranch_scc1 pg_5
    s_setprio 1
    s_branch pg_4
pg_5:
    ds_read_b32 v99, v97
    s_waitcnt lgkmcnt(0)
    v_cmp_gt_u32 vcc, v98, v99
    s_cmp_lg_u32 vcc_lo, 0
    s_cbranch_scc1 pg_5
    s_branch pg_4
pg_9:
    s_cmp_lg_u32 vcc_lo, 0
    s_cbranch_scc1 pg_8
    s_setprio 1
    s_branch pg_7
pg_8:
    ds_read_b32 v99, v97
    s_waitcnt lgkmcnt(0)
    v_cmp_gt_u32 vcc, v98, v99
    s_cmp_lg_u32 vcc_lo, 0
    s_cbranch_scc1 pg_8
    s_branch pg_7
pg_12:
    s_cmp_lg_u32 vcc_lo, 0
    s_cbranch_scc1 pg_11
    s_setprio 1
    s_branch pg_10
pg_11:
    ds_read_b32 v99, v97
    s_waitcnt lgkmcnt(0)
    v_cmp_gt_u32 vcc, v98, v99
    s_cmp_lg_u32 vcc_lo, 0
    s_cbranch_scc1 pg_11
    s_branch pg_10
B_ost_g:
    buffer_store_dwordx2 v[64:65], v93, s[64:67], s14 offen offset:0 sc1
    buffer_store_dwordx2 v[66:67], v93, s[64:67], s14 offen offset:512 sc1
    buffer_store_dwordx2 v[68:69], v93, s[64:67], s14 offen offset:1024 sc1
    s_mov_b32 exec_hi, 0
    buffer_store_dwordx2 v[70:71], v93, s[64:67], s14 offen offset:1536 sc1
    s_mov_b32 exec_hi, -1
    s_branch B_ost_d
B_fl_g:
    buffer_store_dwordx2 v[124:125], v127, s[64:67], s12 offen sc1
    s_branch B_fl_d
B_takv:
    v_lshl_add_u32 v100, v9, 9, v100
    v_lshl_add_u32 v100, v8, 6, v100
    s_lshl_b32 s8, s61, 10
    s_add_u32 s8, s8, 0x800
    v_add_u32 v100, s8, v100
    v_add_u32 v101, 256, v100
    s_mov_b32 s101, s61
    s_branch B_tad
B_qv:
    s_waitcnt vmcnt(12)
    s_barrier
    ds_read_b128 v[32:35], v96 offset:0
    ds_read_b64_tr_b16 v[36:37], v100 offset:0
    ds_read_b64_tr_b16 v[38:39], v101 offset:0
    ds_read_b128 v[40:43], v97 offset:0
    ds_read_b64_tr_b16 v[44:45], v100 offset:4096
    ds_read_b64_tr_b16 v[46:47], v101 offset:4096
    ds_read_b128 v[48:51], v98 offset:0
    ds_read_b64_tr_b16 v[52:53], v100 offset:8192
    ds_read_b64_tr_b16 v[54:55], v101 offset:8192
    ds_read_b128 v[56:59], v99 offset:0
    ds_read_b64_tr_b16 v[60:61], v100 offset:12288
    ds_read_b64_tr_b16 v[62:63], v101 offset:12288
    ds_read_b128 v[64:67], v96 offset:16384
    ds_read_b64_tr_b16 v[68:69], v100 offset:16384
    ds_read_b64_tr_b16 v[70:71], v101 offset:16384
    s_waitcnt lgkmcnt(12)
    v_mfma_f32_32x32x16_bf16 v[16:31], v[32:35], v[36:39], 0
    ds_read_b128 v[72:75], v97 offset:16384
    ds_read_b64_tr_b16 v[76:77], v100 offset:20480
    ds_read_b64_tr_b16 v[78:79], v101 offset:20480
    s_waitcnt lgkmcnt(12)
    v_mfma_f32_32x32x16_bf16 v[16:31], v[40:43], v[44:47], v[16:31]
    ds_read_b128 v[80:83], v98 offset:16384
    ds_read_b64_tr_b16 v[84:85], v100 offset:24576
    ds_read_b64_tr_b16 v[86:87], v101 offset:24576
    s_waitcnt lgkmcnt(12)
    v_mfma_f32_32x32x16_bf16 v[16:31], v[48:51], v[52:55], v[16:31]
    ds_read_b128 v[88:91], v99 offset:16384
    ds_read_b64_tr_b16 v[92:93], v100 offset:28672
    ds_read_b64_tr_b16 v[94:95], v101 offset:28672
    s_waitcnt lgkmcnt(12)
    v_mfma_f32_32x32x16_bf16 v[16:31], v[56:59], v[60:63], v[16:31]
    s_waitcnt lgkmcnt(9)
    v_mfma_f32_32x32x16_bf16 v[16:31], v[64:67], v[68:71], v[16:31]
    s_waitcnt lgkmcnt(6)
    v_mfma_f32_32x32x16_bf16 v[16:31], v[72:75], v[76:79], v[16:31]
    s_waitcnt lgkmcnt(3)
    v_mfma_f32_32x32x16_bf16 v[16:31], v[80:83], v[84:87], v[16:31]
    s_waitcnt lgkmcnt(0)
    v_mfma_f32_32x32x16_bf16 v[16:31], v[88:91], v[92:95], v[16:31]
    s_waitcnt vmcnt(0)
    s_barrier
    ds_read_b128 v[32:35], v96 offset:32768
    ds_read_b64_tr_b16 v[36:37], v100 offset:32768
    ds_read_b64_tr_b16 v[38:39], v101 offset:32768
    ds_read_b128 v[40:43], v97 offset:32768
    ds_read_b64_tr_b16 v[44:45], v100 offset:36864
    ds_read_b64_tr_b16 v[46:47], v101 offset:36864
    ds_read_b128 v[48:51], v98 offset:32768
    ds_read_b64_tr_b16 v[52:53], v100 offset:40960
    ds_read_b64_tr_b16 v[54:55], v101 offset:40960
    ds_read_b128 v[56:59], v99 offset:32768
    ds_read_b64_tr_b16 v[60:61], v100 offset:45056
    ds_read_b64_tr_b16 v[62:63], v101 offset:45056
    s_add_u32 m0, s9, 0
    s_lshl_b32 s8, s15, 7
    s_add_u32 s14, s12, s8
    buffer_load_dwordx4 v4, s[52:55], s14 offen lds
    buffer_load_dwordx4 v5, s[52:55], s14 offen offset:1024 lds
    s_mul_i32 s8, s15, s50
    s_add_u32 s14, s13, s8
    buffer_load_dwordx4 v6, s[56:59], s14 offen offset:2048 lds
    buffer_load_dwordx4 v7, s[72:75], s14 offen offset:3072 lds
    s_add_u32 s15, s15, 1
    s_cmp_eq_u32 s15, 7
    s_cselect_b32 s15, 0, s15
    s_add_u32 m0, s9, 16384
    s_lshl_b32 s8, s15, 7
    s_add_u32 s14, s12, s8
    buffer_load_dwordx4 v4, s[52:55], s14 offen lds
    buffer_load_dwordx4 v5, s[52:55], s14 offen offset:1024 lds
    s_mul_i32 s8, s15, s50
    s_add_u32 s14, s13, s8
    buffer_load_dwordx4 v6, s[56:59], s14 offen offset:2048 lds
    buffer_load_dwordx4 v7, s[72:75], s14 offen offset:3072 lds
    s_add_u32 s15, s15, 1
    s_cmp_eq_u32 s15, 7
    s_cselect_b32 s15, 0, s15
    buffer_load_dwordx2 v[124:125], v127, s[68:71], 0 offen sc1
    ds_read_b128 v[64:67], v96 offset:49152
    ds_read_b64_tr_b16 v[68:69], v100 offset:49152
    ds_read_b64_tr_b16 v[70:71], v101 offset:49152
    s_waitcnt lgkmcnt(12)
    v_mfma_f32_32x32x16_bf16 v[16:31], v[32:35], v[36:39], v[16:31]
    ds_read_b128 v[72:75], v97 offset:49152
    ds_read_b64_tr_b16 v[76:77], v100 offset:53248
    ds_read_b64_tr_b16 v[78:79], v101 offset:53248
    s_waitcnt lgkmcnt(12)
    v_mfma_f32_32x32x16_bf16 v[16:31], v[40:43], v[44:47], v[16:31]
    ds_read_b128 v[80:83], v98 offset:49152
    ds_read_b64_tr_b16 v[84:85], v100 offset:57344
    ds_read_b64_tr_b16 v[86:87], v101 offset:57344
    s_waitcnt lgkmcnt(12)
    v_mfma_f32_32x32x16_bf16 v[16:31], v[48:51], v[52:55], v[16:31]
    ds_read_b128 v[88:91], v99 offset:49152
    ds_read_b64_tr_b16 v[92:93], v100 offset:61440
    ds_read_b64_tr_b16 v[94:95], v101 offset:61440
    s_waitcnt lgkmcnt(12)
    v_mfma_f32_32x32x16_bf16 v[16:31], v[56:59], v[60:63], v[16:31]
    ds_read_b128 v[32:35], v102 offset:0
    ds_read_b64_tr_b16 v[36:37], v106 offset:0
    ds_read_b64_tr_b16 v[38:39], v107 offset:0
    s_waitcnt lgkmcnt(12)
    v_mfma_f32_32x32x16_bf16 v[16:31], v[64:67], v[68:71], v[16:31]
    ds_read_b128 v[40:43], v103 offset:0
    ds_read_b64_tr_b16 v[44:45], v106 offset:4096
    ds_read_b64_tr_b16 v[46:47], v107 offset:4096
    s_waitcnt lgkmcnt(12)
    v_mfma_f32_32x32x16_bf16 v[16:31], v[72:75], v[76:79], v[16:31]
    ds_read_b128 v[48:51], v104 offset:0
    ds_read_b64_tr_b16 v[52:53], v106 offset:8192
    ds_read_b64_tr_b16 v[54:55], v107 offset:8192
    s_waitcnt lgkmcnt(12)
    v_mfma_f32_32x32x16_bf16 v[16:31], v[80:83], v[84:87], v[16:31]
    ds_read_b128 v[56:59], v105 offset:0
    ds_read_b64_tr_b16 v[60:61], v106 offset:12288
    ds_read_b64_tr_b16 v[62:63], v107 offset:12288
    s_waitcnt lgkmcnt(12)
    v_mfma_f32_32x32x16_bf16 v[16:31], v[88:91], v[92:95], v[16:31]
    s_waitcnt lgkmcnt(9)
    v_mfma_f32_32x32x16_bf16 v[16:31], v[32:35], v[36:39], v[16:31]
    s_waitcnt lgkmcnt(6)
    v_mfma_f32_32x32x16_bf16 v[16:31], v[40:43], v[44:47], v[16:31]
    s_waitcnt lgkmcnt(3)
    v_mfma_f32_32x32x16_bf16 v[16:31], v[48:51], v[52:55], v[16:31]
    s_waitcnt lgkmcnt(0)
    v_mfma_f32_32x32x16_bf16 v[16:31], v[56:59], v[60:63], v[16:31]
    s_waitcnt vmcnt(5)
    s_barrier
    ds_read_b128 v[64:67], v96 offset:0
    ds_read_b64_tr_b16 v[68:69], v100 offset:0
    ds_read_b64_tr_b16 v[70:71], v101 offset:0
    ds_read_b128 v[72:75], v97 offset:0
    ds_read_b64_tr_b16 v[76:77], v100 offset:4096
    ds_read_b64_tr_b16 v[78:79], v101 offset:4096
    ds_read_b128 v[80:83], v98 offset:0
    ds_read_b64_tr_b16 v[84:85], v100 offset:8192
    ds_read_b64_tr_b16 v[86:87], v101 offset:8192
    ds_read_b128 v[88:91], v99 offset:0
    ds_read_b64_tr_b16 v[92:93], v100 offset:12288
    ds_read_b64_tr_b16 v[94:95], v101 offset:12288
    s_waitcnt lgkmcnt(9)
    v_mfma_f32_32x32x16_bf16 v[16:31], v[64:67], v[68:71], v[16:31]
    s_waitcnt lgkmcnt(6)
    v_mfma_f32_32x32x16_bf16 v[16:31], v[72:75], v[76:79], v[16:31]
    s_waitcnt lgkmcnt(3)
    v_mfma_f32_32x32x16_bf16 v[16:31], v[80:83], v[84:87], v[16:31]
    s_waitcnt lgkmcnt(0)
    v_mfma_f32_32x32x16_bf16 v[16:31], v[88:91], v[92:95], v[16:31]
    s_waitcnt vmcnt(1)
    s_barrier
    ds_read_b128 v[32:35], v96 offset:16384
    ds_read_b64_tr_b16 v[36:37], v100 offset:16384
    ds_read_b64_tr_b16 v[38:39], v101 offset:16384
    ds_read_b128 v[40:43], v97 offset:16384
    ds_read_b64_tr_b16 v[44:45], v100 offset:20480
    ds_read_b64_tr_b16 v[46:47], v101 offset:20480
    ds_read_b128 v[48:51], v98 offset:16384
    ds_read_b64_tr_b16 v[52:53], v100 offset:24576
    ds_read_b64_tr_b16 v[54:55], v101 offset:24576
    ds_read_b128 v[56:59], v99 offset:16384
    ds_read_b64_tr_b16 v[60:61], v100 offset:28672
    ds_read_b64_tr_b16 v[62:63], v101 offset:28672
    s_waitcnt lgkmcnt(9)
    v_mfma_f32_32x32x16_bf16 v[16:31], v[32:35], v[36:39], v[16:31]
    s_waitcnt lgkmcnt(6)
    v_mfma_f32_32x32x16_bf16 v[16:31], v[40:43], v[44:47], v[16:31]
    s_waitcnt lgkmcnt(3)
    v_mfma_f32_32x32x16_bf16 v[16:31], v[48:51], v[52:55], v[16:31]
    s_waitcnt lgkmcnt(0)
    v_mfma_f32_32x32x16_bf16 v[16:31], v[56:59], v[60:63], v[16:31]
    v_lshlrev_b32 v2, 4, v1
    s_nop 11
    v_cvt_pk_bf16_f32 v32, v16, v17
    v_cvt_pk_bf16_f32 v33, v18, v19
    v_cvt_pk_bf16_f32 v34, v20, v21
    v_cvt_pk_bf16_f32 v35, v22, v23
    v_cvt_pk_bf16_f32 v36, v24, v25
    v_cvt_pk_bf16_f32 v37, v26, v27
    v_cvt_pk_bf16_f32 v38, v28, v29
    v_cvt_pk_bf16_f32 v39, v30, v31
    s_mov_b32 exec_lo, 0x10000000
    s_mov_b32 exec_hi, 0x10000000
    v_mov_b32 v32, 0x3f803f80
    v_mov_b32 v33, 0x3f803f80
    v_mov_b32 v34, 0x3f803f80
    v_mov_b32 v35, 0x3f803f80
    v_mov_b32 v36, 0x3f803f80
    v_mov_b32 v37, 0x3f803f80
    v_mov_b32 v38, 0x3f803f80
    v_mov_b32 v39, 0x3f803f80
    s_mov_b32 exec_lo, 0xe0000000
    s_mov_b32 exec_hi, 0xe0000000
    v_mov_b32 v32, 0
    v_mov_b32 v33, 0
    v_mov_b32 v34, 0
    v_mov_b32 v35, 0
    v_mov_b32 v36, 0
    v_mov_b32 v37, 0
    v_mov_b32 v38, 0
    v_mov_b32 v39, 0
    s_branch B_ekvs
B_ek:
    s_nop 9
    v_cvt_pk_bf16_f32 v32, v16, v17
    v_cvt_pk_bf16_f32 v33, v18, v19
    v_cvt_pk_bf16_f32 v34, v20, v21
    v_cvt_pk_bf16_f32 v35, v22, v23
    v_cvt_pk_bf16_f32 v36, v24, v25
    v_cvt_pk_bf16_f32 v37, v26, v27
    v_cvt_pk_bf16_f32 v38, v28, v29
    v_cvt_pk_bf16_f32 v39, v30, v31
    s_mov_b32 exec_lo, 0
    v_mov_b32 v38, 0x3f803f80
    v_mov_b32 v39, 0
B_ekvs:
    s_mov_b64 exec, -1
    s_lshl_b32 s12, s6, 1
    s_and_b32 s8, s3, 1
    s_add_u32 s12, s12, s8
    s_lshl_b32 s13, s12, 12
    s_lshl_b32 s8, s61, 11
    s_add_u32 s13, s13, s8
    s_add_u32 s13, s13, 8192
    buffer_store_dwordx4 v[32:35], v2, s[64:67], s13 offen sc1
    buffer_store_dwordx4 v[36:39], v2, s[64:67], s13 offen offset:1024 sc1
    s_lshl_b32 s8, s6, 7
    s_add_u32 s8, s8, 311296
    s_waitcnt vmcnt(0)
    s_barrier
    s_cmp_lg_u32 s3, 0
    s_cbranch_scc1 B_cprep
    v_cmp_ne_u32 vcc, 0, v125
    s_cbranch_vccnz tk_16
tk_15:
    buffer_load_dwordx2 v[124:125], v127, s[68:71], 0 offen sc1
    s_waitcnt vmcnt(0)
    v_cmp_ne_u32 vcc, 0, v125
    s_cbranch_vccnz tk_16
    s_sleep 1
    s_add_u32 s100, s100, 1
    s_cmp_lt_u32 s100, 2097152
    s_cbranch_scc1 tk_15
tk_16:
    s_mov_b64 exec, 1
    buffer_store_dwordx2 v[124:125], v127, s[64:67], s8 offen sc1
    s_mov_b64 exec, -1
B_cprep:
    s_cmp_ge_u32 s6, 28
    s_cbranch_scc1 L_fin
    s_setprio 0
    s_cmp_ge_u32 s6, 14
    s_cselect_b32 s56, s28, s26
    s_cselect_b32 s57, s29, s27
    s_cselect_b32 s8, 14, 0
    s_cselect_b32 s13, 28672, 0
    s_mov_b32 s58, 401408
    s_sub_u32 s8, s6, s8
    s_mul_i32 s12, s8, 28672
    s_mul_i32 s14, s3, 224
    s_add_u32 s12, s12, s14
    s_mul_i32 s8, s8, 57344
    s_add_u32 s13, s13, s8
    s_mul_i32 s8, s3, 7168
    s_add_u32 s13, s13, s8
    s_add_u32 s13, s13, 6422528
    s_add_u32 s14, s13, 4096
    v_and_b32 v4, 31, v1
    v_mul_u32_u24 v4, 896, v4
    v_lshrrev_b32 v5, 5, v1
    v_lshl_add_u32 v4, v5, 4, v4
    buffer_load_dwordx4 v[32:35], v4, s[56:59], s12 offen offset:0
    buffer_load_dwordx4 v[36:39], v4, s[56:59], s12 offen offset:32
    buffer_load_dwordx4 v[40:43], v4, s[56:59], s12 offen offset:64
    buffer_load_dwordx4 v[44:47], v4, s[56:59], s12 offen offset:96
    buffer_load_dwordx4 v[48:51], v4, s[56:59], s12 offen offset:128
    buffer_load_dwordx4 v[52:55], v4, s[56:59], s12 offen offset:160
    buffer_load_dwordx4 v[56:59], v4, s[56:59], s12 offen offset:192
    s_waitcnt vmcnt(0)
    buffer_store_dwordx4 v[32:35], v2, s[64:67], s13 offen offset:0 sc1
    buffer_store_dwordx4 v[36:39], v2, s[64:67], s13 offen offset:1024 sc1
    buffer_store_dwordx4 v[40:43], v2, s[64:67], s13 offen offset:2048 sc1
    buffer_store_dwordx4 v[44:47], v2, s[64:67], s13 offen offset:3072 sc1
    buffer_store_dwordx4 v[48:51], v2, s[64:67], s14 offen offset:0 sc1
    buffer_store_dwordx4 v[52:55], v2, s[64:67], s14 offen offset:1024 sc1
    buffer_store_dwordx4 v[56:59], v2, s[64:67], s14 offen offset:2048 sc1
    s_lshl_b32 s8, s6, 7
    s_add_u32 s8, s8, 360448
    s_waitcnt vmcnt(0)
    s_barrier
    s_cmp_lg_u32 s3, 0
    s_cbranch_scc1 L_exit
    s_mov_b64 exec, 1
    buffer_store_dwordx2 v[124:125], v127, s[64:67], s8 offen sc1
    s_mov_b64 exec, -1
    s_endpgm
B_idle:
    v_lshlrev_b32 v2, 4, v1
    s_waitcnt lgkmcnt(0)
    s_mov_b32 s64, s48
    s_mov_b32 s65, s49
    s_mov_b32 s66, 0x6f0000
    s_mov_b32 s67, 0x00020000
    s_mov_b32 s68, s46
    s_mov_b32 s69, s47
    s_mov_b32 s70, 0x100
    s_mov_b32 s71, 0x00020000
    s_cmp_ge_u32 s3, 8
    s_cbranch_scc1 B_loader
    s_barrier
    s_barrier
    s_barrier
    s_barrier
    s_branch B_qdone
B_loader:
    s_setprio 3
    s_and_b32 s11, s3, 1
    s_lshl_b32 s9, s11, 15
    s_lshl_b32 s8, s11, 2
    s_add_u32 s8, s8, 81888
    v_mov_b32 v96, s8
    v_and_b32 v97, 3, v1
    s_lshl_b32 s8, s11, 2
    v_add_u32 v97, s8, v97
    v_lshlrev_b32 v97, 2, v97
    v_add_u32 v97, 81856, v97
    s_barrier
    s_barrier
    s_barrier
tk_17:
    buffer_load_dwordx2 v[124:125], v127, s[68:71], 0 offen sc1
    s_waitcnt vmcnt(0)
    v_cmp_ne_u32 vcc, 0, v125
    s_cbranch_vccnz tk_18
    s_sleep 1
    s_add_u32 s100, s100, 1
    s_cmp_lt_u32 s100, 2097152
    s_cbranch_scc1 tk_17
tk_18:
    s_barrier
    s_cmp_lg_u32 s3, 8
    s_cbranch_scc1 L_nopoll
    v_lshlrev_b32 v5, 7, v1
    s_mov_b32 s14, 311296
    s_mov_b32 exec_lo, -1
    s_mov_b32 exec_hi, 0
    s_mov_b32 s100, 0
    buffer_load_dwordx2 v[104:105], v5, s[64:67], s14 offen sc1
    s_sleep 1
    buffer_load_dwordx2 v[106:107], v5, s[64:67], s14 offen sc1
pp_19:
    s_waitcnt vmcnt(1)
    v_cmp_ne_u64 vcc, v[104:105], v[124:125]
    s_cbranch_vccz pp_20
    buffer_load_dwordx2 v[104:105], v5, s[64:67], s14 offen sc1
    s_waitcnt vmcnt(1)
    v_cmp_ne_u64 vcc, v[106:107], v[124:125]
    s_cbranch_vccz pp_20
    buffer_load_dwordx2 v[106:107], v5, s[64:67], s14 offen sc1
    s_add_u32 s100, s100, 1
    s_cmp_lt_u32 s100, 2097152
    s_cbranch_scc1 pp_19
pp_20:
    s_mov_b64 exec, -1
L_nopoll:
    s_mov_b32 s52, s48
    s_mov_b32 s53, s49
    s_mov_b32 s54, 0x42000
    s_mov_b32 s55, 0x00020000
    v_add_u32 v8, 8192, v2
    v_add_u32 v9, 8192, v2
    v_add_u32 v10, 10240, v2
    v_add_u32 v11, 10240, v2
    v_add_u32 v12, 6144, v2
    v_add_u32 v13, 6144, v2
    v_add_u32 v14, 1024, v2
    v_add_u32 v15, 7168, v2
    s_lshl_b32 s12, s11, 17
    s_mov_b32 s15, 8192
    s_barrier
L_start:
    s_add_u32 m0, s9, 0
    s_nop 0
    buffer_load_dwordx4 v8, s[52:55], s12 offen offset:0 sc1 lds
    buffer_load_dwordx4 v9, s[52:55], s12 offen offset:1024 sc1 lds
    buffer_load_dwordx4 v10, s[52:55], s12 offen offset:2048 sc1 lds
    buffer_load_dwordx4 v11, s[52:55], s12 offen offset:3072 sc1 lds
    s_add_u32 m0, s9, 4096
    s_nop 0
    buffer_load_dwordx4 v15, s[52:55], s12 offen offset:3072 sc1 lds
    s_add_u32 s12, s12, s15
    s_add_u32 m0, s9, 8192
    s_nop 0
    buffer_load_dwordx4 v8, s[52:55], s12 offen offset:0 sc1 lds
    buffer_load_dwordx4 v9, s[52:55], s12 offen offset:1024 sc1 lds
    buffer_load_dwordx4 v10, s[52:55], s12 offen offset:2048 sc1 lds
    buffer_load_dwordx4 v11, s[52:55], s12 offen offset:3072 sc1 lds
    s_add_u32 m0, s9, 12288
    s_nop 0
    buffer_load_dwordx4 v12, s[52:55], s12 offen offset:0 sc1 lds
    buffer_load_dwordx4 v13, s[52:55], s12 offen offset:1024 sc1 lds
    buffer_load_dwordx4 v14, s[52:55], s12 offen offset:2048 sc1 lds
    buffer_load_dwordx4 v15, s[52:55], s12 offen offset:3072 sc1 lds
    s_add_u32 s12, s12, s15
    ds_write_b32 v96, v127
    s_waitcnt vmcnt(8) lgkmcnt(0)
    s_barrier
    s_add_u32 m0, s9, 16384
    s_nop 0
    buffer_load_dwordx4 v8, s[52:55], s12 offen offset:0 sc1 lds
    buffer_load_dwordx4 v9, s[52:55], s12 offen offset:1024 sc1 lds
    buffer_load_dwordx4 v10, s[52:55], s12 offen offset:2048 sc1 lds
    buffer_load_dwordx4 v11, s[52:55], s12 offen offset:3072 sc1 lds
    s_add_u32 m0, s9, 20480
    s_nop 0
    buffer_load_dwordx4 v12, s[52:55], s12 offen offset:0 sc1 lds
    buffer_load_dwordx4 v13, s[52:55], s12 offen offset:1024 sc1 lds
    buffer_load_dwordx4 v14, s[52:55], s12 offen offset:2048 sc1 lds
    buffer_load_dwordx4 v15, s[52:55], s12 offen offset:3072 sc1 lds
    s_add_u32 s12, s12, s15
    s_add_u32 m0, s9, 24576
    s_nop 0
    buffer_load_dwordx4 v8, s[52:55], s12 offen offset:0 sc1 lds
    buffer_load_dwordx4 v9, s[52:55], s12 offen offset:1024 sc1 lds
    buffer_load_dwordx4 v10, s[52:55], s12 offen offset:2048 sc1 lds
    buffer_load_dwordx4 v11, s[52:55], s12 offen offset:3072 sc1 lds
    s_add_u32 m0, s9, 28672
    s_nop 0
    buffer_load_dwordx4 v12, s[52:55], s12 offen offset:0 sc1 lds
    buffer_load_dwordx4 v13, s[52:55], s12 offen offset:1024 sc1 lds
    buffer_load_dwordx4 v14, s[52:55], s12 offen offset:2048 sc1 lds
    buffer_load_dwordx4 v15, s[52:55], s12 offen offset:3072 sc1 lds
    s_add_u32 s12, s12, s15
    v_mov_b32 v98, 1
    s_mov_b32 s61, 1
    s_waitcnt vmcnt(16) lgkmcnt(0)
    s_barrier
    s_waitcnt vmcnt(8)
    ds_write_b32 v96, v98
    s_mov_b32 s13, 0
L_loop:
ls_21:
    ds_read_b32 v99, v97
    s_waitcnt lgkmcnt(0)
    v_cmp_gt_u32 vcc, s61, v99
    s_cbranch_vccz ls_22
    s_sleep 3
    s_branch ls_21
ls_22:
    s_add_u32 m0, s9, 0
    s_nop 0
    buffer_load_dwordx4 v8, s[52:55], s12 offen offset:0 sc1 lds
    buffer_load_dwordx4 v9, s[52:55], s12 offen offset:1024 sc1 lds
    buffer_load_dwordx4 v10, s[52:55], s12 offen offset:2048 sc1 lds
    buffer_load_dwordx4 v11, s[52:55], s12 offen offset:3072 sc1 lds
    s_add_u32 m0, s9, 4096
    s_nop 0
    buffer_load_dwordx4 v12, s[52:55], s12 offen offset:0 sc1 lds
    buffer_load_dwordx4 v13, s[52:55], s12 offen offset:1024 sc1 lds
    buffer_load_dwordx4 v14, s[52:55], s12 offen offset:2048 sc1 lds
    buffer_load_dwordx4 v15, s[52:55], s12 offen offset:3072 sc1 lds
    s_add_u32 s12, s12, s15
    s_add_u32 s61, s61, 1
    v_add_u32 v98, 1, v98
    s_waitcnt vmcnt(8)
    ds_write_b32 v96, v98
ls_23:
    ds_read_b32 v99, v97
    s_waitcnt lgkmcnt(0)
    v_cmp_gt_u32 vcc, s61, v99
    s_cbranch_vccz ls_24
    s_sleep 3
    s_branch ls_23
ls_24:
    s_cmp_eq_u32 s13, 3
    s_cbranch_scc1 L_wo
    s_cmp_eq_u32 s13, 0
    s_cbranch_scc1 L_hello
    s_cmp_eq_u32 s13, 2
    s_cbranch_scc1 L_hchk
L_ret:
    s_add_u32 m0, s9, 8192
    s_nop 0
    buffer_load_dwordx4 v8, s[52:55], s12 offen offset:0 sc1 lds
    buffer_load_dwordx4 v9, s[52:55], s12 offen offset:1024 sc1 lds
    buffer_load_dwordx4 v10, s[52:55], s12 offen offset:2048 sc1 lds
    buffer_load_dwordx4 v11, s[52:55], s12 offen offset:3072 sc1 lds
    s_add_u32 m0, s9, 12288
    s_nop 0
    buffer_load_dwordx4 v12, s[52:55], s12 offen offset:0 sc1 lds
    buffer_load_dwordx4 v13, s[52:55], s12 offen offset:1024 sc1 lds
    buffer_load_dwordx4 v14, s[52:55], s12 offen offset:2048 sc1 lds
    buffer_load_dwordx4 v15, s[52:55], s12 offen offset:3072 sc1 lds
    s_add_u32 s12, s12, s15
    s_add_u32 s61, s61, 1
    v_add_u32 v98, 1, v98
    s_waitcnt vmcnt(8)
    ds_write_b32 v96, v98
ls_25:
    ds_read_b32 v99, v97
    s_waitcnt lgkmcnt(0)
    v_cmp_gt_u32 vcc, s61, v99
    s_cbranch_vccz ls_26
    s_sleep 3
    s_branch ls_25
ls_26:
    s_add_u32 m0, s9, 16384
    s_nop 0
    buffer_load_dwordx4 v8, s[52:55], s12 offen offset:0 sc1 lds
    buffer_load_dwordx4 v9, s[52:55], s12 offen offset:1024 sc1 lds
    buffer_load_dwordx4 v10, s[52:55], s12 offen offset:2048 sc1 lds
    buffer_load_dwordx4 v11, s[52:55], s12 offen offset:3072 sc1 lds
    s_add_u32 m0, s9, 20480
    s_nop 0
    buffer_load_dwordx4 v12, s[52:55], s12 offen offset:0 sc1 lds
    buffer_load_dwordx4 v13, s[52:55], s12 offen offset:1024 sc1 lds
    buffer_load_dwordx4 v14, s[52:55], s12 offen offset:2048 sc1 lds
    buffer_load_dwordx4 v15, s[52:55], s12 offen offset:3072 sc1 lds
    s_add_u32 s12, s12, s15
    s_add_u32 s61, s61, 1
    v_add_u32 v98, 1, v98
    s_waitcnt vmcnt(8)
    ds_write_b32 v96, v98
ls_27:
    ds_read_b32 v99, v97
    s_waitcnt lgkmcnt(0)
    v_cmp_gt_u32 vcc, s61, v99
    s_cbranch_vccz ls_28
    s_sleep 3
    s_branch ls_27
ls_28:
    s_add_u32 s8, s13, s11
    s_cmp_eq_u32 s8, 4
    s_cbranch_scc1 L_done
    s_add_u32 m0, s9, 24576
    s_nop 0
    buffer_load_dwordx4 v8, s[52:55], s12 offen offset:0 sc1 lds
    buffer_load_dwordx4 v9, s[52:55], s12 offen offset:1024 sc1 lds
    buffer_load_dwordx4 v10, s[52:55], s12 offen offset:2048 sc1 lds
    buffer_load_dwordx4 v11, s[52:55], s12 offen offset:3072 sc1 lds
    s_add_u32 m0, s9, 28672
    s_nop 0
    buffer_load_dwordx4 v12, s[52:55], s12 offen offset:0 sc1 lds
    buffer_load_dwordx4 v13, s[52:55], s12 offen offset:1024 sc1 lds
    buffer_load_dwordx4 v14, s[52:55], s12 offen offset:2048 sc1 lds
    buffer_load_dwordx4 v15, s[52:55], s12 offen offset:3072 sc1 lds
    s_add_u32 s12, s12, s15
    s_add_u32 s61, s61, 1
    v_add_u32 v98, 1, v98
    s_waitcnt vmcnt(8)
    ds_write_b32 v96, v98
    s_add_u32 s13, s13, 1
    s_cmp_lt_u32 s13, 4
    s_cbranch_scc1 L_loop
L_done:
    s_lshl_b32 s12, s7, 7
    s_waitcnt lgkmcnt(0)
    s_barrier
    s_add_u32 m0, s9, 0
    s_nop 0
    buffer_load_dwordx4 v8, s[52:55], s12 offen offset:0 sc1 lds
    buffer_load_dwordx4 v9, s[52:55], s12 offen offset:1024 sc1 lds
    buffer_load_dwordx4 v10, s[52:55], s12 offen offset:2048 sc1 lds
    buffer_load_dwordx4 v11, s[52:55], s12 offen offset:3072 sc1 lds
    s_add_u32 m0, s9, 4096
    s_nop 0
    buffer_load_dwordx4 v12, s[52:55], s12 offen offset:0 sc1 lds
    buffer_load_dwordx4 v13, s[52:55], s12 offen offset:1024 sc1 lds
    buffer_load_dwordx4 v14, s[52:55], s12 offen offset:2048 sc1 lds
    buffer_load_dwordx4 v15, s[52:55], s12 offen offset:3072 sc1 lds
    s_add_u32 s12, s12, s15
    v_and_b32 v7, 3, v1
    v_lshlrev_b32 v7, 2, v7
    v_add_u32 v7, 81856, v7
    s_waitcnt vmcnt(0)
    s_barrier
    ds_read_b32 v7, v7
    s_waitcnt lgkmcnt(0)
    v_cmp_ne_u32 vcc, 0, v7
    s_cbranch_vccz L_exit
    s_mov_b32 s52, s48
    s_mov_b32 s53, s49
    s_mov_b32 s54, 0x42000
    s_mov_b32 s55, 0x00020000
    v_add_u32 v8, 8192, v2
    v_add_u32 v9, 8192, v2
    v_add_u32 v10, 10240, v2
    v_add_u32 v11, 10240, v2
    v_add_u32 v12, 6144, v2
    v_add_u32 v13, 6144, v2
    v_add_u32 v14, 1024, v2
    v_add_u32 v15, 7168, v2
    s_lshl_b32 s12, s11, 17
    s_mov_b32 s15, 8192
    s_mov_b32 s13, 16
    s_barrier
L_mloop:
    s_add_u32 m0, s9, 0
    s_nop 0
    buffer_load_dwordx4 v8, s[52:55], s12 offen offset:0 sc1 lds
    buffer_load_dwordx4 v9, s[52:55], s12 offen offset:1024 sc1 lds
    buffer_load_dwordx4 v10, s[52:55], s12 offen offset:2048 sc1 lds
    buffer_load_dwordx4 v11, s[52:55], s12 offen offset:3072 sc1 lds
    s_add_u32 m0, s9, 4096
    s_nop 0
    buffer_load_dwordx4 v12, s[52:55], s12 offen offset:0 sc1 lds
    buffer_load_dwordx4 v13, s[52:55], s12 offen offset:1024 sc1 lds
    buffer_load_dwordx4 v14, s[52:55], s12 offen offset:2048 sc1 lds
    buffer_load_dwordx4 v15, s[52:55], s12 offen offset:3072 sc1 lds
    s_add_u32 s12, s12, s15
    s_waitcnt vmcnt(0)
    s_barrier
    s_barrier
    s_sub_u32 s13, s13, 1
    s_cmp_lg_u32 s13, 0
    s_cbranch_scc1 L_mloop
    s_mov_b32 s52, s48
    s_mov_b32 s53, s49
    s_mov_b32 s54, 0x42000
    s_mov_b32 s55, 0x00020000
    v_add_u32 v8, 8192, v2
    v_add_u32 v9, 8192, v2
    v_add_u32 v10, 10240, v2
    v_add_u32 v11, 10240, v2
    v_add_u32 v12, 6144, v2
    v_add_u32 v13, 6144, v2
    v_add_u32 v14, 1024, v2
    v_add_u32 v15, 7168, v2
    s_lshl_b32 s12, s11, 17
    s_mov_b32 s15, 8192
    s_barrier
    s_barrier
    s_branch L_start
L_wo:
    s_mov_b32 s52, s42
    s_mov_b32 s53, s43
    s_mov_b32 s54, 401408
    s_lshl_b32 s8, s11, 8
    v_lshrrev_b32 v3, 3, v1
    v_add_u32 v3, s8, v3
    v_mul_u32_u24 v3, 896, v3
    v_bfe_u32 v5, v1, 4, 1
    v_lshlrev_b32 v5, 2, v5
    v_and_b32 v6, 7, v1
    v_xor_b32 v5, v5, v6
    v_lshl_add_u32 v3, v5, 4, v3
    s_lshl_b32 s12, s7, 7
    s_mov_b32 s15, 57344
    s_add_u32 s12, s12, s15
    v_add_u32 v8, 0, v3
    v_add_u32 v9, 6144, v3
    v_add_u32 v10, 12288, v3
    v_add_u32 v11, 18432, v3
    v_add_u32 v12, 28672, v3
    v_add_u32 v13, 34816, v3
    v_add_u32 v14, 40960, v3
    v_add_u32 v15, 47104, v3
    s_branch L_ret
L_hello:
    s_cmp_lg_u32 s3, 8
    s_cbranch_scc1 L_ret
    s_getreg_b32 s8, hwreg(HW_REG_XCC_ID)
    s_and_b32 s8, s8, 15
    v_mov_b32 v126, s8
    s_lshl_b32 s8, s6, 3
    s_add_u32 s8, s8, s7
    s_lshl_b32 s8, s8, 6
    s_add_u32 s8, s8, 409600
    s_mov_b64 exec, 1
    buffer_store_dwordx4 v[124:127], v127, s[64:67], s8 offen sc1
    s_mov_b64 exec, -1
    s_branch L_ret
L_hchk:
    s_cmp_lg_u32 s3, 8
    s_cbranch_scc1 L_opf
    s_lshl_b32 s14, s6, 9
    s_add_u32 s14, s14, 409600
    v_and_b32 v5, 7, v1
    v_lshlrev_b32 v5, 6, v5
    buffer_load_dwordx4 v[100:103], v5, s[64:67], s14 offen sc1
    v_mov_b32 v5, 81896
    s_waitcnt vmcnt(0)
    v_cmp_ne_u64 vcc, v[100:101], v[124:125]
    v_cmp_ne_u32 s[50:51], v126, v102
    s_or_b64 vcc, vcc, s[50:51]
    s_cselect_b32 s8, 0, 1
    v_mov_b32 v6, s8
    ds_write_b32 v5, v6
    s_branch L_ret
L_opf:
    s_mul_i32 s14, s6, 57344
    s_mul_i32 s8, s7, 7168
    s_add_u32 s14, s14, s8
    s_add_u32 s14, s14, 786432
    s_add_u32 s8, s14, 3072
    buffer_load_dwordx4 v[100:103], v2, s[64:67], s14 offen offset:0 sc1
    buffer_load_dwordx4 v[100:103], v2, s[64:67], s14 offen offset:1024 sc1
    buffer_load_dwordx4 v[104:107], v2, s[64:67], s8 offen offset:1024 sc1
    buffer_load_dwordx4 v[100:103], v2, s[64:67], s14 offen offset:2048 sc1
    buffer_load_dwordx4 v[104:107], v2, s[64:67], s8 offen offset:2048 sc1
    buffer_load_dwordx4 v[100:103], v2, s[64:67], s14 offen offset:3072 sc1
    buffer_load_dwordx4 v[104:107], v2, s[64:67], s8 offen offset:3072 sc1
    s_branch L_ret
B_slow:
    s_mov_b32 s13, 16
    v_mov_b32 v88, 0xff800000
    s_barrier
B_mloop:
    s_barrier
    ds_read_b128 v[72:75], v4 offset:0
    ds_read_b128 v[76:79], v4 offset:1024
    s_waitcnt lgkmcnt(0)
    v_mfma_f32_32x32x16_bf16 v[32:47], v[72:75], v[8:11], 0
    v_mfma_f32_32x32x16_bf16 v[32:47], v[76:79], v[12:15], v[32:47]
    s_nop 15
    v_max3_f32 v88, v88, v32, v33
    v_max3_f32 v88, v88, v34, v35
    v_max3_f32 v88, v88, v36, v37
    v_max3_f32 v88, v88, v38, v39
    v_max3_f32 v88, v88, v40, v41
    v_max3_f32 v88, v88, v42, v43
    v_max3_f32 v88, v88, v44, v45
    v_max3_f32 v88, v88, v46, v47
    ds_read_b128 v[72:75], v4 offset:2048
    ds_read_b128 v[76:79], v4 offset:3072
    s_waitcnt lgkmcnt(0)
    v_mfma_f32_32x32x16_bf16 v[32:47], v[72:75], v[8:11], 0
    v_mfma_f32_32x32x16_bf16 v[32:47], v[76:79], v[12:15], v[32:47]
    s_nop 15
    v_max3_f32 v88, v88, v32, v33
    v_max3_f32 v88, v88, v34, v35
    v_max3_f32 v88, v88, v36, v37
    v_max3_f32 v88, v88, v38, v39
    v_max3_f32 v88, v88, v40, v41
    v_max3_f32 v88, v88, v42, v43
    v_max3_f32 v88, v88, v44, v45
    v_max3_f32 v88, v88, v46, v47
    s_barrier
    s_sub_u32 s13, s13, 1
    s_cmp_lg_u32 s13, 0
    s_cbranch_scc1 B_mloop
    v_lshlrev_b32 v89, 2, v1
    s_lshl_b32 s8, s3, 8
    v_add_u32 v90, s8, v89
    ds_write_b32 v90, v88
    s_lshl_b32 s8, s10, 8
    v_and_b32 v89, 127, v89
    v_add_u32 v90, s8, v89
    s_waitcnt lgkmcnt(0)
    s_barrier
    ds_read_b32 v88, v90
    ds_read_b32 v89, v90 offset:128
    ds_read_b32 v91, v90 offset:1024
    ds_read_b32 v92, v90 offset:1152
    s_waitcnt lgkmcnt(0)
    v_max_f32 v88, v88, v89
    v_max3_f32 v88, v88, v91, v92
    v_sub_f32 v88, 0, v88
    v_and_b32 v89, 0xffff0000, v88
    v_sub_f32 v88, v88, v89
    v_cvt_pk_bf16_f32 v88, v89, v88
    s_mov_b32 exec_lo, 0
    v_mov_b32 v14, v88
    s_mov_b32 exec_lo, -1
    s_mov_b32 s63, 1
    s_barrier
    s_branch B_start
L_roleA:
    s_setprio 0
    s_lshr_b32 s10, s4, 1
    s_lshl_b32 s10, s10, 2
    s_and_b32 s8, s6, 3
    s_add_u32 s10, s10, s8
    s_and_b32 s8, s4, 1
    s_mul_i32 s8, s8, 7
    s_add_u32 s11, s7, s8
    s_lshl_b32 s8, s11, 5
    v_and_b32 v16, 31, v1
    v_add_u32 v16, s8, v16
    v_lshlrev_b32 v17, 1, v16
    v_lshrrev_b32 v4, 2, v2
    v_lshlrev_b32 v4, 4, v4
    v_and_b32 v7, 1, v2
    v_lshl_add_u32 v4, v7, 3, v4
    v_bfe_u32 v7, v2, 1, 1
    s_lshl_b32 s8, s3, 5
    v_add3_u32 v4, v4, v7, s8
    v_mul_u32_u24 v4, 896, v4
    v_add_u32 v4, v4, v3
    v_xor_b32 v5, 64, v4
    v_add_u32 v6, 1536, v4
    v_add_u32 v7, 2304, v5
    v_add_u32 v5, 768, v5
    s_lshl_b32 s8, s3, 3
    v_add_u32 v22, s8, v2
    v_mul_u32_u24 v22, 896, v22
    v_add_u32 v22, v22, v3
    s_and_b32 s8, s3, 1
    s_lshl_b32 s8, s8, 6
    v_xor_b32 v22, s8, v22
    s_mul_i32 s12, s10, 114688
    s_mul_i32 s13, s11, 28672
    s_and_b32 s8, s6, 3
    s_lshl_b32 s8, s8, 1
    s_add_u32 s15, s7, s8
    s_cmp_ge_u32 s15, 7
    s_cselect_b32 s8, 7, 0
    s_sub_u32 s15, s15, s8
    s_lshl_b32 s15, s15, 7
    s_lshl_b32 s62, s3, 11
    s_waitcnt lgkmcnt(0)
    s_mov_b32 s68, s46
    s_mov_b32 s69, s47
    s_mov_b32 s70, 0x100
    s_mov_b32 s71, 0x00020000
    s_mov_b32 s64, s48
    s_mov_b32 s65, s49
    s_mov_b32 s66, 0x6f0000
    s_mov_b32 s67, 0x00020000
    s_mov_b32 s72, s18
    s_mov_b32 s73, s19
    s_mov_b32 s74, 0x380
    s_mov_b32 s75, 0x00020000
    s_mov_b32 s76, s20
    s_mov_b32 s77, s21
    s_mov_b32 s78, 0x380
    s_mov_b32 s79, 0x00020000
    buffer_load_ushort v18, v17, s[72:75], 0 offen
    buffer_load_ushort v19, v17, s[76:79], 0 offen
    s_mov_b32 s72, s30
    s_mov_b32 s73, s31
    buffer_load_ushort v20, v17, s[72:75], 0 offen
    s_mov_b32 s52, s16
    s_mov_b32 s53, s17
    s_mov_b32 s54, 0x1c0000
    s_mov_b32 s55, 0x00020000
    s_mov_b32 s56, s22
    s_mov_b32 s57, s23
    s_mov_b32 s58, 0x62000
    s_mov_b32 s59, 0x00020000
    s_sub_u32 s76, s24, 1024
    s_subb_u32 s77, s25, 0
    s_mov_b32 s78, 402432
    s_mov_b32 s79, 0x00020000
    v_bfe_u32 v2, v1, 4, 1
    v_lshlrev_b32 v3, 11, v2
    v_and_b32 v2, 15, v1
    v_lshl_add_u32 v3, v2, 7, v3
    v_add_u32 v3, s9, v3
    v_bfe_u32 v2, v1, 1, 3
    v_lshrrev_b32 v8, 5, v1
    v_xor_b32 v2, v2, v8
    v_xor_b32 v8, 0, v2
    v_lshl_add_u32 v8, v8, 4, v3
    v_xor_b32 v9, 2, v2
    v_lshl_add_u32 v9, v9, 4, v3
    v_xor_b32 v10, 4, v2
    v_lshl_add_u32 v10, v10, 4, v3
    v_xor_b32 v11, 6, v2
    v_lshl_add_u32 v11, v11, 4, v3
    v_bfe_u32 v2, v1, 3, 2
    v_lshlrev_b32 v3, 11, v2
    v_and_b32 v2, 7, v1
    v_lshl_add_u32 v3, v2, 7, v3
    v_add_u32 v3, 0x4000, v3
    v_bfe_u32 v2, v1, 1, 3
    v_lshrrev_b32 v12, 5, v1
    v_xor_b32 v2, v2, v12
    v_xor_b32 v12, 0, v2
    v_lshl_add_u32 v12, v12, 4, v3
    v_xor_b32 v13, 2, v2
    v_lshl_add_u32 v13, v13, 4, v3
    v_xor_b32 v14, 4, v2
    v_lshl_add_u32 v14, v14, 4, v3
    v_xor_b32 v15, 6, v2
    v_lshl_add_u32 v15, v15, 4, v3
    s_add_u32 m0, s9, 0
    s_add_u32 s14, s12, s15
    buffer_load_dwordx4 v4, s[52:55], s14 offen lds
    buffer_load_dwordx4 v5, s[52:55], s14 offen offset:1024 lds
    buffer_load_dwordx4 v6, s[52:55], s14 offen offset:2048 lds
    buffer_load_dwordx4 v7, s[52:55], s14 offen offset:3072 lds
    s_add_u32 m0, s62, 16384
    s_add_u32 s14, s13, s15
    buffer_load_dwordx4 v22, s[56:59], s14 offen lds
    buffer_load_dwordx4 v22, s[76:79], s14 offen offset:1024 lds
    s_add_u32 s15, s15, 128
    s_cmp_eq_u32 s15, 896
    s_cselect_b32 s15, 0, s15
    s_add_u32 m0, s9, 24576
    s_add_u32 s14, s12, s15
    buffer_load_dwordx4 v4, s[52:55], s14 offen lds
    buffer_load_dwordx4 v5, s[52:55], s14 offen offset:1024 lds
    buffer_load_dwordx4 v6, s[52:55], s14 offen offset:2048 lds
    buffer_load_dwordx4 v7, s[52:55], s14 offen offset:3072 lds
    s_add_u32 m0, s62, 40960
    s_add_u32 s14, s13, s15
    buffer_load_dwordx4 v22, s[56:59], s14 offen lds
    buffer_load_dwordx4 v22, s[76:79], s14 offen offset:1024 lds
    s_add_u32 s15, s15, 128
    s_cmp_eq_u32 s15, 896
    s_cselect_b32 s15, 0, s15
    s_add_u32 m0, s9, 49152
    s_add_u32 s14, s12, s15
    buffer_load_dwordx4 v4, s[52:55], s14 offen lds
    buffer_load_dwordx4 v5, s[52:55], s14 offen offset:1024 lds
    buffer_load_dwordx4 v6, s[52:55], s14 offen offset:2048 lds
    buffer_load_dwordx4 v7, s[52:55], s14 offen offset:3072 lds
    s_add_u32 m0, s62, 65536
    s_add_u32 s14, s13, s15
    buffer_load_dwordx4 v22, s[56:59], s14 offen lds
    buffer_load_dwordx4 v22, s[76:79], s14 offen offset:1024 lds
    s_add_u32 s15, s15, 128
    s_cmp_eq_u32 s15, 896
    s_cselect_b32 s15, 0, s15
    s_waitcnt vmcnt(18)
    v_lshlrev_b32 v18, 16, v18
    v_lshlrev_b32 v19, 16, v19
    v_lshlrev_b32 v20, 16, v20
    v_mul_f32 v20, 0x3fb8aa3b, v20
    v_exp_f32 v20, v20
    s_nop 0
    v_cvt_pk_bf16_f32 v20, v20, v20
    v_and_b32 v20, 0xffff0000, v20
    v_mul_f32 v21, v20, v18
    v_mul_f32 v17, v20, v19
    v_mul_f32 v21, 0x3fb8aa3b, v21
    v_mul_f32 v17, 0x3e22f983, v17
    v_exp_f32 v23, v21
    v_fract_f32 v25, v17
    v_cos_f32 v24, v25
    v_sin_f32 v25, v25
    s_nop 0
    v_mul_f32 v24, v24, v23
    v_mul_f32 v25, v25, v23
    v_mul_f32 v23, 0x41800000, v21
    v_mul_f32 v27, 0x41800000, v17
    v_exp_f32 v23, v23
    v_fract_f32 v27, v27
    v_cos_f32 v26, v27
    v_sin_f32 v27, v27
    s_nop 0
    v_mul_f32 v26, v26, v23
    v_mul_f32 v27, v27, v23
    v_mul_f32 v23, 0x41000000, v21
    v_mul_f32 v29, 0x41000000, v17
    v_exp_f32 v23, v23
    v_fract_f32 v29, v29
    v_cos_f32 v28, v29
    v_sin_f32 v29, v29
    s_nop 0
    v_mul_f32 v28, v28, v23
    v_mul_f32 v29, v29, v23
    v_lshrrev_b32 v20, 5, v1
    s_lshl_b32 s8, s3, 1
    v_add_u32 v20, s8, v20
    v_lshlrev_b32 v2, 4, v20
    v_cvt_f32_u32 v2, v2
    v_mul_f32 v23, v2, v21
    v_mul_f32 v113, v2, v17
    v_exp_f32 v23, v23
    v_fract_f32 v113, v113
    v_cos_f32 v112, v113
    v_sin_f32 v113, v113
    s_nop 0
    v_mul_f32 v112, v112, v23
    v_mul_f32 v113, v113, v23
    s_sub_u32 s8, s10, 1
    v_sub_u32 v3, s8, v20
    v_subrev_u32 v3, 0, v3
    v_max_i32 v2, 0, v3
    v_lshlrev_b32 v2, 7, v2
    v_cvt_f32_u32 v2, v2
    v_mul_f32 v23, v2, v21
    v_mul_f32 v115, v2, v17
    v_exp_f32 v23, v23
    v_fract_f32 v115, v115
    v_cos_f32 v114, v115
    v_sin_f32 v115, v115
    s_nop 0
    v_mul_f32 v114, v114, v23
    v_mul_f32 v115, v115, v23
    v_cmp_gt_i32 vcc, 0, v3
    v_add_u32 v120, 0, v20
    v_min_i32 v120, s8, v120
    v_cndmask_b32 v114, v114, v127, vcc
    v_cndmask_b32 v115, v115, v127, vcc
    v_mul_u32_u24 v120, 7168, v120
    v_lshl_add_u32 v120, v16, 4, v120
    v_sub_u32 v3, s8, v20
    v_subrev_u32 v3, 8, v3
    v_max_i32 v2, 0, v3
    v_lshlrev_b32 v2, 7, v2
    v_cvt_f32_u32 v2, v2
    v_mul_f32 v23, v2, v21
    v_mul_f32 v117, v2, v17
    v_exp_f32 v23, v23
    v_fract_f32 v117, v117
    v_cos_f32 v116, v117
    v_sin_f32 v117, v117
    s_nop 0
    v_mul_f32 v116, v116, v23
    v_mul_f32 v117, v117, v23
    v_cmp_gt_i32 vcc, 0, v3
    v_add_u32 v121, 8, v20
    v_min_i32 v121, s8, v121
    v_cndmask_b32 v116, v116, v127, vcc
    v_cndmask_b32 v117, v117, v127, vcc
    v_mul_u32_u24 v121, 7168, v121
    v_lshl_add_u32 v121, v16, 4, v121
    v_add_f32 v3, -1.0, v24
    v_mul_f32 v23, v18, v18
    v_fmac_f32 v23, v19, v19
    v_rcp_f32 v23, v23
    v_mul_f32 v118, v3, v18
    v_fmac_f32 v118, v25, v19
    v_mul_f32 v119, v25, v18
    v_mul_f32 v2, v3, v19
    v_sub_f32 v119, v119, v2
    v_add_f32 v23, v23, v23
    v_mul_f32 v118, v118, v23
    v_mul_f32 v119, v119, v23
    v_and_b32 v2, 31, v1
    v_lshlrev_b32 v2, 3, v2
    v_lshl_add_u32 v3, v20, 8, v2
    v_lshrrev_b32 v20, 5, v1
    v_lshlrev_b32 v17, 4, v20
    v_bfe_u32 v18, v1, 2, 3
    v_lshl_add_u32 v17, v18, 8, v17
    v_and_b32 v18, 3, v1
    v_lshl_add_u32 v17, v18, 5, v17
    s_add_u32 s8, s9, 49152
    v_add_u32 v17, s8, v17
    v_lshlrev_b32 v20, 9, v20
    v_add3_u32 v20, v20, v2, s8
    v_lshlrev_b32 v18, 4, v16
    s_setprio 3
    s_waitcnt vmcnt(12)
    s_barrier
    ds_read_b128 v[64:67], v8 offset:0
    ds_read_b128 v[80:83], v12 offset:0
    ds_read_b128 v[96:99], v12 offset:1024
    ds_read_b128 v[68:71], v9 offset:0
    ds_read_b128 v[84:87], v13 offset:0
    ds_read_b128 v[100:103], v13 offset:1024
    ds_read_b128 v[72:75], v10 offset:0
    ds_read_b128 v[88:91], v14 offset:0
    ds_read_b128 v[104:107], v14 offset:1024
    ds_read_b128 v[76:79], v11 offset:0
    ds_read_b128 v[92:95], v15 offset:0
    ds_read_b128 v[108:111], v15 offset:1024
    s_waitcnt lgkmcnt(9)
    v_mfma_f32_32x32x16_bf16 v[32:47], v[64:67], v[80:83], 0
    v_mfma_f32_32x32x16_bf16 v[48:63], v[64:67], v[96:99], 0
    s_waitcnt lgkmcnt(6)
    v_mfma_f32_32x32x16_bf16 v[32:47], v[68:71], v[84:87], v[32:47]
    v_mfma_f32_32x32x16_bf16 v[48:63], v[68:71], v[100:103], v[48:63]
    s_waitcnt lgkmcnt(3)
    v_mfma_f32_32x32x16_bf16 v[32:47], v[72:75], v[88:91], v[32:47]
    v_mfma_f32_32x32x16_bf16 v[48:63], v[72:75], v[104:107], v[48:63]
    s_waitcnt lgkmcnt(0)
    v_mfma_f32_32x32x16_bf16 v[32:47], v[76:79], v[92:95], v[32:47]
    v_mfma_f32_32x32x16_bf16 v[48:63], v[76:79], v[108:111], v[48:63]
    s_waitcnt vmcnt(6)
    s_barrier
    ds_read_b128 v[64:67], v8 offset:24576
    ds_read_b128 v[80:83], v12 offset:24576
    ds_read_b128 v[96:99], v12 offset:25600
    ds_read_b128 v[68:71], v9 offset:24576
    ds_read_b128 v[84:87], v13 offset:24576
    ds_read_b128 v[100:103], v13 offset:25600
    ds_read_b128 v[72:75], v10 offset:24576
    ds_read_b128 v[88:91], v14 offset:24576
    ds_read_b128 v[104:107], v14 offset:25600
    ds_read_b128 v[76:79], v11 offset:24576
    ds_read_b128 v[92:95], v15 offset:24576
    ds_read_b128 v[108:111], v15 offset:25600
    buffer_load_dwordx2 v[124:125], v127, s[68:71], 0 offen sc1
    s_add_u32 m0, s9, 0
    s_add_u32 s14, s12, s15
    buffer_load_dwordx4 v4, s[52:55], s14 offen lds
    buffer_load_dwordx4 v5, s[52:55], s14 offen offset:1024 lds
    buffer_load_dwordx4 v6, s[52:55], s14 offen offset:2048 lds
    buffer_load_dwordx4 v7, s[52:55], s14 offen offset:3072 lds
    s_add_u32 m0, s62, 16384
    s_add_u32 s14, s13, s15
    buffer_load_dwordx4 v22, s[56:59], s14 offen lds
    buffer_load_dwordx4 v22, s[76:79], s14 offen offset:1024 lds
    s_add_u32 s15, s15, 128
    s_cmp_eq_u32 s15, 896
    s_cselect_b32 s15, 0, s15
    s_waitcnt lgkmcnt(9)
    v_mfma_f32_32x32x16_bf16 v[32:47], v[64:67], v[80:83], v[32:47]
    v_mfma_f32_32x32x16_bf16 v[48:63], v[64:67], v[96:99], v[48:63]
    s_waitcnt lgkmcnt(6)
    v_mfma_f32_32x32x16_bf16 v[32:47], v[68:71], v[84:87], v[32:47]
    v_mfma_f32_32x32x16_bf16 v[48:63], v[68:71], v[100:103], v[48:63]
    s_waitcnt lgkmcnt(3)
    v_mfma_f32_32x32x16_bf16 v[32:47], v[72:75], v[88:91], v[32:47]
    v_mfma_f32_32x32x16_bf16 v[48:63], v[72:75], v[104:107], v[48:63]
    s_waitcnt lgkmcnt(0)
    v_mfma_f32_32x32x16_bf16 v[32:47], v[76:79], v[92:95], v[32:47]
    v_mfma_f32_32x32x16_bf16 v[48:63], v[76:79], v[108:111], v[48:63]
    s_waitcnt vmcnt(7)
    s_barrier
    ds_read_b128 v[64:67], v8 offset:49152
    ds_read_b128 v[80:83], v12 offset:49152
    ds_read_b128 v[96:99], v12 offset:50176
    ds_read_b128 v[68:71], v9 offset:49152
    ds_read_b128 v[84:87], v13 offset:49152
    ds_read_b128 v[100:103], v13 offset:50176
    ds_read_b128 v[72:75], v10 offset:49152
    ds_read_b128 v[88:91], v14 offset:49152
    ds_read_b128 v[104:107], v14 offset:50176
    ds_read_b128 v[76:79], v11 offset:49152
    ds_read_b128 v[92:95], v15 offset:49152
    ds_read_b128 v[108:111], v15 offset:50176
    s_add_u32 m0, s9, 24576
    s_add_u32 s14, s12, s15
    buffer_load_dwordx4 v4, s[52:55], s14 offen lds
    buffer_load_dwordx4 v5, s[52:55], s14 offen offset:1024 lds
    buffer_load_dwordx4 v6, s[52:55], s14 offen offset:2048 lds
    buffer_load_dwordx4 v7, s[52:55], s14 offen offset:3072 lds
    s_add_u32 m0, s62, 40960
    s_add_u32 s14, s13, s15
    buffer_load_dwordx4 v22, s[56:59], s14 offen lds
    buffer_load_dwordx4 v22, s[76:79], s14 offen offset:1024 lds
    s_add_u32 s15, s15, 128
    s_cmp_eq_u32 s15, 896
    s_cselect_b32 s15, 0, s15
    s_waitcnt lgkmcnt(9)
    v_mfma_f32_32x32x16_bf16 v[32:47], v[64:67], v[80:83], v[32:47]
    v_mfma_f32_32x32x16_bf16 v[48:63], v[64:67], v[96:99], v[48:63]
    s_waitcnt lgkmcnt(6)
    v_mfma_f32_32x32x16_bf16 v[32:47], v[68:71], v[84:87], v[32:47]
    v_mfma_f32_32x32x16_bf16 v[48:63], v[68:71], v[100:103], v[48:63]
    s_waitcnt lgkmcnt(3)
    v_mfma_f32_32x32x16_bf16 v[32:47], v[72:75], v[88:91], v[32:47]
    v_mfma_f32_32x32x16_bf16 v[48:63], v[72:75], v[104:107], v[48:63]
    s_waitcnt lgkmcnt(0)
    v_mfma_f32_32x32x16_bf16 v[32:47], v[76:79], v[92:95], v[32:47]
    v_mfma_f32_32x32x16_bf16 v[48:63], v[76:79], v[108:111], v[48:63]
    s_waitcnt vmcnt(6)
    s_barrier
    ds_read_b128 v[64:67], v8 offset:0
    ds_read_b128 v[80:83], v12 offset:0
    ds_read_b128 v[96:99], v12 offset:1024
    ds_read_b128 v[68:71], v9 offset:0
    ds_read_b128 v[84:87], v13 offset:0
    ds_read_b128 v[100:103], v13 offset:1024
    ds_read_b128 v[72:75], v10 offset:0
    ds_read_b128 v[88:91], v14 offset:0
    ds_read_b128 v[104:107], v14 offset:1024
    ds_read_b128 v[76:79], v11 offset:0
    ds_read_b128 v[92:95], v15 offset:0
    ds_read_b128 v[108:111], v15 offset:1024
    v_cmp_ne_u32 vcc, 0, v125
    s_cbranch_vccnz tk_30
tk_29:
    buffer_load_dwordx2 v[124:125], v127, s[68:71], 0 offen sc1
    s_waitcnt vmcnt(0)
    v_cmp_ne_u32 vcc, 0, v125
    s_cbranch_vccnz tk_30
    s_sleep 1
    s_add_u32 s100, s100, 1
    s_cmp_lt_u32 s100, 2097152
    s_cbranch_scc1 tk_29
tk_30:
    s_add_u32 m0, s9, 49152
    s_add_u32 s14, s12, s15
    buffer_load_dwordx4 v4, s[52:55], s14 offen lds
    buffer_load_dwordx4 v5, s[52:55], s14 offen offset:1024 lds
    buffer_load_dwordx4 v6, s[52:55], s14 offen offset:2048 lds
    buffer_load_dwordx4 v7, s[52:55], s14 offen offset:3072 lds
    s_add_u32 m0, s62, 65536
    s_add_u32 s14, s13, s15
    buffer_load_dwordx4 v22, s[56:59], s14 offen lds
    buffer_load_dwordx4 v22, s[76:79], s14 offen offset:1024 lds
    s_add_u32 s15, s15, 128
    s_cmp_eq_u32 s15, 896
    s_cselect_b32 s15, 0, s15
    s_waitcnt lgkmcnt(9)
    v_mfma_f32_32x32x16_bf16 v[32:47], v[64:67], v[80:83], v[32:47]
    v_mfma_f32_32x32x16_bf16 v[48:63], v[64:67], v[96:99], v[48:63]
    s_waitcnt lgkmcnt(6)
    v_mfma_f32_32x32x16_bf16 v[32:47], v[68:71], v[84:87], v[32:47]
    v_mfma_f32_32x32x16_bf16 v[48:63], v[68:71], v[100:103], v[48:63]
    s_waitcnt lgkmcnt(3)
    v_mfma_f32_32x32x16_bf16 v[32:47], v[72:75], v[88:91], v[32:47]
    v_mfma_f32_32x32x16_bf16 v[48:63], v[72:75], v[104:107], v[48:63]
    s_waitcnt lgkmcnt(0)
    v_mfma_f32_32x32x16_bf16 v[32:47], v[76:79], v[92:95], v[32:47]
    v_mfma_f32_32x32x16_bf16 v[48:63], v[76:79], v[108:111], v[48:63]
    s_waitcnt vmcnt(6)
    s_barrier
    ds_read_b128 v[64:67], v8 offset:24576
    ds_read_b128 v[80:83], v12 offset:24576
    ds_read_b128 v[96:99], v12 offset:25600
    ds_read_b128 v[68:71], v9 offset:24576
    ds_read_b128 v[84:87], v13 offset:24576
    ds_read_b128 v[100:103], v13 offset:25600
    ds_read_b128 v[72:75], v10 offset:24576
    ds_read_b128 v[88:91], v14 offset:24576
    ds_read_b128 v[104:107], v14 offset:25600
    ds_read_b128 v[76:79], v11 offset:24576
    ds_read_b128 v[92:95], v15 offset:24576
    ds_read_b128 v[108:111], v15 offset:25600
    s_add_u32 m0, s9, 0
    s_add_u32 s14, s12, s15
    buffer_load_dwordx4 v4, s[52:55], s14 offen lds
    buffer_load_dwordx4 v5, s[52:55], s14 offen offset:1024 lds
    buffer_load_dwordx4 v6, s[52:55], s14 offen offset:2048 lds
    buffer_load_dwordx4 v7, s[52:55], s14 offen offset:3072 lds
    s_add_u32 m0, s62, 16384
    s_add_u32 s14, s13, s15
    buffer_load_dwordx4 v22, s[56:59], s14 offen lds
    buffer_load_dwordx4 v22, s[76:79], s14 offen offset:1024 lds
    s_add_u32 s15, s15, 128
    s_cmp_eq_u32 s15, 896
    s_cselect_b32 s15, 0, s15
    s_waitcnt lgkmcnt(9)
    v_mfma_f32_32x32x16_bf16 v[32:47], v[64:67], v[80:83], v[32:47]
    v_mfma_f32_32x32x16_bf16 v[48:63], v[64:67], v[96:99], v[48:63]
    s_waitcnt lgkmcnt(6)
    v_mfma_f32_32x32x16_bf16 v[32:47], v[68:71], v[84:87], v[32:47]
    v_mfma_f32_32x32x16_bf16 v[48:63], v[68:71], v[100:103], v[48:63]
    s_waitcnt lgkmcnt(3)
    v_mfma_f32_32x32x16_bf16 v[32:47], v[72:75], v[88:91], v[32:47]
    v_mfma_f32_32x32x16_bf16 v[48:63], v[72:75], v[104:107], v[48:63]
    s_waitcnt lgkmcnt(0)
    v_mfma_f32_32x32x16_bf16 v[32:47], v[76:79], v[92:95], v[32:47]
    v_mfma_f32_32x32x16_bf16 v[48:63], v[76:79], v[108:111], v[48:63]
    s_waitcnt vmcnt(6)
    s_barrier
    ds_read_b128 v[64:67], v8 offset:49152
    ds_read_b128 v[80:83], v12 offset:49152
    ds_read_b128 v[96:99], v12 offset:50176
    ds_read_b128 v[68:71], v9 offset:49152
    ds_read_b128 v[84:87], v13 offset:49152
    ds_read_b128 v[100:103], v13 offset:50176
    ds_read_b128 v[72:75], v10 offset:49152
    ds_read_b128 v[88:91], v14 offset:49152
    ds_read_b128 v[104:107], v14 offset:50176
    ds_read_b128 v[76:79], v11 offset:49152
    ds_read_b128 v[92:95], v15 offset:49152
    ds_read_b128 v[108:111], v15 offset:50176
    s_waitcnt lgkmcnt(9)
    v_mfma_f32_32x32x16_bf16 v[32:47], v[64:67], v[80:83], v[32:47]
    v_mfma_f32_32x32x16_bf16 v[48:63], v[64:67], v[96:99], v[48:63]
    s_waitcnt lgkmcnt(6)
    v_mfma_f32_32x32x16_bf16 v[32:47], v[68:71], v[84:87], v[32:47]
    v_mfma_f32_32x32x16_bf16 v[48:63], v[68:71], v[100:103], v[48:63]
    s_waitcnt lgkmcnt(3)
    v_mfma_f32_32x32x16_bf16 v[32:47], v[72:75], v[88:91], v[32:47]
    v_mfma_f32_32x32x16_bf16 v[48:63], v[72:75], v[104:107], v[48:63]
    s_waitcnt lgkmcnt(0)
    v_mfma_f32_32x32x16_bf16 v[32:47], v[76:79], v[92:95], v[32:47]
    v_mfma_f32_32x32x16_bf16 v[48:63], v[76:79], v[108:111], v[48:63]
    s_waitcnt vmcnt(0)
    s_barrier
    ds_read_b128 v[64:67], v8 offset:0
    ds_read_b128 v[80:83], v12 offset:0
    ds_read_b128 v[96:99], v12 offset:1024
    ds_read_b128 v[68:71], v9 offset:0
    ds_read_b128 v[84:87], v13 offset:0
    ds_read_b128 v[100:103], v13 offset:1024
    ds_read_b128 v[72:75], v10 offset:0
    ds_read_b128 v[88:91], v14 offset:0
    ds_read_b128 v[104:107], v14 offset:1024
    ds_read_b128 v[76:79], v11 offset:0
    ds_read_b128 v[92:95], v15 offset:0
    ds_read_b128 v[108:111], v15 offset:1024
    s_waitcnt lgkmcnt(9)
    v_mfma_f32_32x32x16_bf16 v[32:47], v[64:67], v[80:83], v[32:47]
    v_mfma_f32_32x32x16_bf16 v[48:63], v[64:67], v[96:99], v[48:63]
    s_waitcnt lgkmcnt(6)
    v_mfma_f32_32x32x16_bf16 v[32:47], v[68:71], v[84:87], v[32:47]
    v_mfma_f32_32x32x16_bf16 v[48:63], v[68:71], v[100:103], v[48:63]
    s_waitcnt lgkmcnt(3)
    v_mfma_f32_32x32x16_bf16 v[32:47], v[72:75], v[88:91], v[32:47]
    v_mfma_f32_32x32x16_bf16 v[48:63], v[72:75], v[104:107], v[48:63]
    s_waitcnt lgkmcnt(0)
    v_mfma_f32_32x32x16_bf16 v[32:47], v[76:79], v[92:95], v[32:47]
    v_mfma_f32_32x32x16_bf16 v[48:63], v[76:79], v[108:111], v[48:63]
    v_mov_b32 v30, 0
    v_mov_b32 v31, 0
    s_nop 11
    v_pk_fma_f32 v[64:65], v[24:25], v[32:33], v[34:35] op_sel_hi:[0,1,1]
    v_pk_fma_f32 v[66:67], v[24:25], v[48:49], v[50:51] op_sel_hi:[0,1,1]
    v_pk_fma_f32 v[64:65], v[24:25], v[48:49], v[64:65] op_sel:[1,0,0] neg_lo:[1,0,0] neg_hi:[1,0,0]
    v_pk_fma_f32 v[66:67], v[24:25], v[32:33], v[66:67] op_sel:[1,0,0]
    v_pk_fma_f32 v[68:69], v[24:25], v[64:65], v[36:37] op_sel_hi:[0,1,1]
    v_pk_fma_f32 v[70:71], v[24:25], v[66:67], v[52:53] op_sel_hi:[0,1,1]
    v_pk_fma_f32 v[68:69], v[24:25], v[66:67], v[68:69] op_sel:[1,0,0] neg_lo:[1,0,0] neg_hi:[1,0,0]
    v_pk_fma_f32 v[70:71], v[24:25], v[64:65], v[70:71] op_sel:[1,0,0]
    v_pk_fma_f32 v[64:65], v[24:25], v[68:69], v[38:39] op_sel_hi:[0,1,1]
    v_pk_fma_f32 v[66:67], v[24:25], v[70:71], v[54:55] op_sel_hi:[0,1,1]
    v_pk_fma_f32 v[64:65], v[24:25], v[70:71], v[64:65] op_sel:[1,0,0] neg_lo:[1,0,0] neg_hi:[1,0,0]
    v_pk_fma_f32 v[66:67], v[24:25], v[68:69], v[66:67] op_sel:[1,0,0]
    v_pk_fma_f32 v[68:69], v[24:25], v[64:65], v[40:41] op_sel_hi:[0,1,1]
    v_pk_fma_f32 v[70:71], v[24:25], v[66:67], v[56:57] op_sel_hi:[0,1,1]
    v_pk_fma_f32 v[68:69], v[24:25], v[66:67], v[68:69] op_sel:[1,0,0] neg_lo:[1,0,0] neg_hi:[1,0,0]
    v_pk_fma_f32 v[70:71], v[24:25], v[64:65], v[70:71] op_sel:[1,0,0]
    v_pk_fma_f32 v[64:65], v[24:25], v[68:69], v[42:43] op_sel_hi:[0,1,1]
    v_pk_fma_f32 v[66:67], v[24:25], v[70:71], v[58:59] op_sel_hi:[0,1,1]
    v_pk_fma_f32 v[64:65], v[24:25], v[70:71], v[64:65] op_sel:[1,0,0] neg_lo:[1,0,0] neg_hi:[1,0,0]
    v_pk_fma_f32 v[66:67], v[24:25], v[68:69], v[66:67] op_sel:[1,0,0]
    v_pk_fma_f32 v[68:69], v[24:25], v[64:65], v[44:45] op_sel_hi:[0,1,1]
    v_pk_fma_f32 v[70:71], v[24:25], v[66:67], v[60:61] op_sel_hi:[0,1,1]
    v_pk_fma_f32 v[68:69], v[24:25], v[66:67], v[68:69] op_sel:[1,0,0] neg_lo:[1,0,0] neg_hi:[1,0,0]
    v_pk_fma_f32 v[70:71], v[24:25], v[64:65], v[70:71] op_sel:[1,0,0]
    v_pk_fma_f32 v[64:65], v[24:25], v[68:69], v[46:47] op_sel_hi:[0,1,1]
    v_pk_fma_f32 v[66:67], v[24:25], v[70:71], v[62:63] op_sel_hi:[0,1,1]
    v_pk_fma_f32 v[64:65], v[24:25], v[70:71], v[64:65] op_sel:[1,0,0] neg_lo:[1,0,0] neg_hi:[1,0,0]
    v_pk_fma_f32 v[66:67], v[24:25], v[68:69], v[66:67] op_sel:[1,0,0]
    v_mov_b32 v68, v65
    v_mov_b32 v69, v67
    v_fmac_f32 v68, v28, v64
    v_fmac_f32 v69, v28, v66
    v_fma_f32 v68, -v29, v66, v68
    v_fmac_f32 v69, v29, v64
    ds_write_b64 v3, v[68:69] offset:32768
    s_waitcnt lgkmcnt(0)
    s_barrier
    ds_read_b64 v[72:73], v2 offset:32768
    ds_read_b64 v[74:75], v2 offset:33024
    ds_read_b64 v[76:77], v2 offset:33280
    ds_read_b64 v[78:79], v2 offset:33536
    ds_read_b64 v[80:81], v2 offset:33792
    ds_read_b64 v[82:83], v2 offset:34048
    ds_read_b64 v[84:85], v2 offset:34304
    s_mul_i32 s8, s10, 7168
    s_add_u32 s8, s8, 6291456
    s_waitcnt lgkmcnt(0)
    s_cmp_eq_u32 s3, 0
    s_cbranch_scc1 A_pm0
    v_pk_fma_f32 v[70:71], v[26:27], v[30:31], v[72:73] op_sel_hi:[0,1,1]
    v_pk_fma_f32 v[70:71], v[26:27], v[30:31], v[70:71] op_sel:[1,1,0] op_sel_hi:[1,0,1] neg_lo:[1,0,0]
    v_pk_fma_f32 v[30:31], v[26:27], v[70:71], v[74:75] op_sel_hi:[0,1,1]
    v_pk_fma_f32 v[30:31], v[26:27], v[70:71], v[30:31] op_sel:[1,1,0] op_sel_hi:[1,0,1] neg_lo:[1,0,0]
    s_cmp_eq_u32 s3, 1
    s_cbranch_scc1 A_pm2
    v_pk_fma_f32 v[70:71], v[26:27], v[30:31], v[76:77] op_sel_hi:[0,1,1]
    v_pk_fma_f32 v[70:71], v[26:27], v[30:31], v[70:71] op_sel:[1,1,0] op_sel_hi:[1,0,1] neg_lo:[1,0,0]
    v_pk_fma_f32 v[30:31], v[26:27], v[70:71], v[78:79] op_sel_hi:[0,1,1]
    v_pk_fma_f32 v[30:31], v[26:27], v[70:71], v[30:31] op_sel:[1,1,0] op_sel_hi:[1,0,1] neg_lo:[1,0,0]
    s_cmp_eq_u32 s3, 2
    s_cbranch_scc1 A_pm4
    v_pk_fma_f32 v[70:71], v[26:27], v[30:31], v[80:81] op_sel_hi:[0,1,1]
    v_pk_fma_f32 v[70:71], v[26:27], v[30:31], v[70:71] op_sel:[1,1,0] op_sel_hi:[1,0,1] neg_lo:[1,0,0]
    v_pk_fma_f32 v[30:31], v[26:27], v[70:71], v[82:83] op_sel_hi:[0,1,1]
    v_pk_fma_f32 v[30:31], v[26:27], v[70:71], v[30:31] op_sel:[1,1,0] op_sel_hi:[1,0,1] neg_lo:[1,0,0]
A_pm6:
    s_mov_b32 exec_lo, 0
    v_pk_fma_f32 v[70:71], v[26:27], v[30:31], v[84:85] op_sel_hi:[0,1,1]
    v_pk_fma_f32 v[70:71], v[26:27], v[30:31], v[70:71] op_sel:[1,1,0] op_sel_hi:[1,0,1] neg_lo:[1,0,0]
    v_pk_fma_f32 v[122:123], v[26:27], v[70:71], v[68:69] op_sel_hi:[0,1,1]
    v_pk_fma_f32 v[122:123], v[26:27], v[70:71], v[122:123] op_sel:[1,1,0] op_sel_hi:[1,0,1] neg_lo:[1,0,0]
    buffer_store_dwordx4 v[122:125], v18, s[64:67], s8 offen sc1
    v_mov_b32 v30, v70
    v_mov_b32 v31, v71
    s_mov_b32 exec_lo, -1
    s_branch A_pdone
A_pm4:
    s_mov_b32 exec_lo, 0
    v_pk_fma_f32 v[70:71], v[26:27], v[30:31], v[80:81] op_sel_hi:[0,1,1]
    v_pk_fma_f32 v[70:71], v[26:27], v[30:31], v[70:71] op_sel:[1,1,0] op_sel_hi:[1,0,1] neg_lo:[1,0,0]
    v_mov_b32 v30, v70
    v_mov_b32 v31, v71
    s_mov_b32 exec_lo, -1
    s_branch A_pdone
A_pm2:
    s_mov_b32 exec_lo, 0
    v_pk_fma_f32 v[70:71], v[26:27], v[30:31], v[76:77] op_sel_hi:[0,1,1]
    v_pk_fma_f32 v[70:71], v[26:27], v[30:31], v[70:71] op_sel:[1,1,0] op_sel_hi:[1,0,1] neg_lo:[1,0,0]
    v_mov_b32 v30, v70
    v_mov_b32 v31, v71
    s_mov_b32 exec_lo, -1
    s_branch A_pdone
A_pm0:
    s_mov_b32 exec_lo, 0
    v_pk_fma_f32 v[70:71], v[26:27], v[30:31], v[72:73] op_sel_hi:[0,1,1]
    v_pk_fma_f32 v[70:71], v[26:27], v[30:31], v[70:71] op_sel:[1,1,0] op_sel_hi:[1,0,1] neg_lo:[1,0,0]
    v_mov_b32 v30, v70
    v_mov_b32 v31, v71
    s_mov_b32 exec_lo, -1
A_pdone:
    s_cmp_eq_u32 s10, 0
    s_cbranch_scc1 A_hdone
    s_mov_b32 s14, 6291456
    s_mov_b32 s100, 0
A_epoll:
    buffer_load_dwordx4 v[72:75], v120, s[64:67], s14 offen sc1
    buffer_load_dwordx4 v[76:79], v121, s[64:67], s14 offen sc1
    s_waitcnt vmcnt(0)
    v_cmp_ne_u64 vcc, v[74:75], v[124:125]
    v_cmp_ne_u64 s[72:73], v[78:79], v[124:125]
    s_or_b64 vcc, vcc, s[72:73]
    s_cbranch_scc0 A_eok
    s_sleep 4
    s_add_u32 s100, s100, 1
    s_cmp_lt_u32 s100, 2097152
    s_cbranch_scc1 A_epoll
A_eok:
    v_pk_mul_f32 v[70:71], v[114:115], v[72:73] op_sel_hi:[0,1]
    v_pk_fma_f32 v[70:71], v[114:115], v[72:73], v[70:71] op_sel:[1,1,0] op_sel_hi:[1,0,1] neg_lo:[1,0,0]
    v_pk_fma_f32 v[80:81], v[116:117], v[76:77], v[70:71] op_sel_hi:[0,1,1]
    v_pk_fma_f32 v[80:81], v[116:117], v[76:77], v[80:81] op_sel:[1,1,0] op_sel_hi:[1,0,1] neg_lo:[1,0,0]
    ds_write_b64 v3, v[80:81] offset:36864
    s_waitcnt lgkmcnt(0)
    s_barrier
    ds_read_b64 v[72:73], v2 offset:36864
    ds_read_b64 v[74:75], v2 offset:37120
    ds_read_b64 v[76:77], v2 offset:37376
    ds_read_b64 v[78:79], v2 offset:37632
    ds_read_b64 v[80:81], v2 offset:37888
    ds_read_b64 v[82:83], v2 offset:38144
    ds_read_b64 v[84:85], v2 offset:38400
    ds_read_b64 v[86:87], v2 offset:38656
    s_waitcnt lgkmcnt(4)
    v_pk_add_f32 v[72:73], v[72:73], v[74:75]
    v_pk_add_f32 v[76:77], v[76:77], v[78:79]
    s_waitcnt lgkmcnt(0)
    v_pk_add_f32 v[80:81], v[80:81], v[82:83]
    v_pk_add_f32 v[84:85], v[84:85], v[86:87]
    v_pk_add_f32 v[72:73], v[72:73], v[76:77]
    v_pk_add_f32 v[80:81], v[80:81], v[84:85]
    v_pk_add_f32 v[72:73], v[72:73], v[80:81]
    v_pk_fma_f32 v[30:31], v[112:113], v[72:73], v[30:31] op_sel_hi:[0,1,1]
    v_pk_fma_f32 v[30:31], v[112:113], v[72:73], v[30:31] op_sel:[1,1,0] op_sel_hi:[1,0,1] neg_lo:[1,0,0]
A_hdone:
    v_fmac_f32 v64, v28, v30
    v_fmac_f32 v66, v28, v31
    v_fma_f32 v64, -v29, v31, v64
    v_fmac_f32 v66, v29, v30
    v_mov_b32 v65, v64
    v_mov_b32 v67, v66
    v_mov_b32 v64, v30
    v_mov_b32 v66, v31
    v_pk_fma_f32 v[32:33], v[24:25], v[64:65], v[32:33] op_sel_hi:[0,1,1]
    v_pk_fma_f32 v[48:49], v[24:25], v[66:67], v[48:49] op_sel_hi:[0,1,1]
    v_pk_fma_f32 v[32:33], v[24:25], v[66:67], v[32:33] op_sel:[1,0,0] neg_lo:[1,0,0] neg_hi:[1,0,0]
    v_pk_fma_f32 v[48:49], v[24:25], v[64:65], v[48:49] op_sel:[1,0,0]
    v_pk_mul_f32 v[72:73], v[118:119], v[32:33] op_sel_hi:[0,1]
    v_pk_mul_f32 v[88:89], v[118:119], v[48:49] op_sel_hi:[0,1] neg_lo:[1,0] neg_hi:[1,0]
    v_pk_fma_f32 v[72:73], v[118:119], v[48:49], v[72:73] op_sel:[1,0,0] neg_lo:[1,0,0] neg_hi:[1,0,0]
    v_pk_fma_f32 v[88:89], v[118:119], v[32:33], v[88:89] op_sel:[1,0,0] neg_lo:[1,0,0] neg_hi:[1,0,0]
    v_pk_fma_f32 v[34:35], v[24:25], v[32:33], v[34:35] op_sel_hi:[0,1,1]
    v_pk_fma_f32 v[50:51], v[24:25], v[48:49], v[50:51] op_sel_hi:[0,1,1]
    v_pk_fma_f32 v[34:35], v[24:25], v[48:49], v[34:35] op_sel:[1,0,0] neg_lo:[1,0,0] neg_hi:[1,0,0]
    v_pk_fma_f32 v[50:51], v[24:25], v[32:33], v[50:51] op_sel:[1,0,0]
    v_pk_mul_f32 v[74:75], v[118:119], v[34:35] op_sel_hi:[0,1]
    v_pk_mul_f32 v[90:91], v[118:119], v[50:51] op_sel_hi:[0,1] neg_lo:[1,0] neg_hi:[1,0]
    v_pk_fma_f32 v[74:75], v[118:119], v[50:51], v[74:75] op_sel:[1,0,0] neg_lo:[1,0,0] neg_hi:[1,0,0]
    v_pk_fma_f32 v[90:91], v[118:119], v[34:35], v[90:91] op_sel:[1,0,0] neg_lo:[1,0,0] neg_hi:[1,0,0]
    v_pk_fma_f32 v[36:37], v[24:25], v[34:35], v[36:37] op_sel_hi:[0,1,1]
    v_pk_fma_f32 v[52:53], v[24:25], v[50:51], v[52:53] op_sel_hi:[0,1,1]
    v_pk_fma_f32 v[36:37], v[24:25], v[50:51], v[36:37] op_sel:[1,0,0] neg_lo:[1,0,0] neg_hi:[1,0,0]
    v_pk_fma_f32 v[52:53], v[24:25], v[34:35], v[52:53] op_sel:[1,0,0]
    v_pk_mul_f32 v[76:77], v[118:119], v[36:37] op_sel_hi:[0,1]
    v_pk_mul_f32 v[92:93], v[118:119], v[52:53] op_sel_hi:[0,1] neg_lo:[1,0] neg_hi:[1,0]
    v_pk_fma_f32 v[76:77], v[118:119], v[52:53], v[76:77] op_sel:[1,0,0] neg_lo:[1,0,0] neg_hi:[1,0,0]
    v_pk_fma_f32 v[92:93], v[118:119], v[36:37], v[92:93] op_sel:[1,0,0] neg_lo:[1,0,0] neg_hi:[1,0,0]
    v_pk_fma_f32 v[38:39], v[24:25], v[36:37], v[38:39] op_sel_hi:[0,1,1]
    v_pk_fma_f32 v[54:55], v[24:25], v[52:53], v[54:55] op_sel_hi:[0,1,1]
    v_pk_fma_f32 v[38:39], v[24:25], v[52:53], v[38:39] op_sel:[1,0,0] neg_lo:[1,0,0] neg_hi:[1,0,0]
    v_pk_fma_f32 v[54:55], v[24:25], v[36:37], v[54:55] op_sel:[1,0,0]
    v_pk_mul_f32 v[78:79], v[118:119], v[38:39] op_sel_hi:[0,1]
    v_pk_mul_f32 v[94:95], v[118:119], v[54:55] op_sel_hi:[0,1] neg_lo:[1,0] neg_hi:[1,0]
    v_pk_fma_f32 v[78:79], v[118:119], v[54:55], v[78:79] op_sel:[1,0,0] neg_lo:[1,0,0] neg_hi:[1,0,0]
    v_pk_fma_f32 v[94:95], v[118:119], v[38:39], v[94:95] op_sel:[1,0,0] neg_lo:[1,0,0] neg_hi:[1,0,0]
    v_pk_fma_f32 v[40:41], v[24:25], v[38:39], v[40:41] op_sel_hi:[0,1,1]
    v_pk_fma_f32 v[56:57], v[24:25], v[54:55], v[56:57] op_sel_hi:[0,1,1]
    v_pk_fma_f32 v[40:41], v[24:25], v[54:55], v[40:41] op_sel:[1,0,0] neg_lo:[1,0,0] neg_hi:[1,0,0]
    v_pk_fma_f32 v[56:57], v[24:25], v[38:39], v[56:57] op_sel:[1,0,0]
    v_pk_mul_f32 v[80:81], v[118:119], v[40:41] op_sel_hi:[0,1]
    v_pk_mul_f32 v[96:97], v[118:119], v[56:57] op_sel_hi:[0,1] neg_lo:[1,0] neg_hi:[1,0]
    v_pk_fma_f32 v[80:81], v[118:119], v[56:57], v[80:81] op_sel:[1,0,0] neg_lo:[1,0,0] neg_hi:[1,0,0]
    v_pk_fma_f32 v[96:97], v[118:119], v[40:41], v[96:97] op_sel:[1,0,0] neg_lo:[1,0,0] neg_hi:[1,0,0]
    v_pk_fma_f32 v[42:43], v[24:25], v[40:41], v[42:43] op_sel_hi:[0,1,1]
    v_pk_fma_f32 v[58:59], v[24:25], v[56:57], v[58:59] op_sel_hi:[0,1,1]
    v_pk_fma_f32 v[42:43], v[24:25], v[56:57], v[42:43] op_sel:[1,0,0] neg_lo:[1,0,0] neg_hi:[1,0,0]
    v_pk_fma_f32 v[58:59], v[24:25], v[40:41], v[58:59] op_sel:[1,0,0]
    v_pk_mul_f32 v[82:83], v[118:119], v[42:43] op_sel_hi:[0,1]
    v_pk_mul_f32 v[98:99], v[118:119], v[58:59] op_sel_hi:[0,1] neg_lo:[1,0] neg_hi:[1,0]
    v_pk_fma_f32 v[82:83], v[118:119], v[58:59], v[82:83] op_sel:[1,0,0] neg_lo:[1,0,0] neg_hi:[1,0,0]
    v_pk_fma_f32 v[98:99], v[118:119], v[42:43], v[98:99] op_sel:[1,0,0] neg_lo:[1,0,0] neg_hi:[1,0,0]
    v_pk_fma_f32 v[44:45], v[24:25], v[42:43], v[44:45] op_sel_hi:[0,1,1]
    v_pk_fma_f32 v[60:61], v[24:25], v[58:59], v[60:61] op_sel_hi:[0,1,1]
    v_pk_fma_f32 v[44:45], v[24:25], v[58:59], v[44:45] op_sel:[1,0,0] neg_lo:[1,0,0] neg_hi:[1,0,0]
    v_pk_fma_f32 v[60:61], v[24:25], v[42:43], v[60:61] op_sel:[1,0,0]
    v_pk_mul_f32 v[84:85], v[118:119], v[44:45] op_sel_hi:[0,1]
    v_pk_mul_f32 v[100:101], v[118:119], v[60:61] op_sel_hi:[0,1] neg_lo:[1,0] neg_hi:[1,0]
    v_pk_fma_f32 v[84:85], v[118:119], v[60:61], v[84:85] op_sel:[1,0,0] neg_lo:[1,0,0] neg_hi:[1,0,0]
    v_pk_fma_f32 v[100:101], v[118:119], v[44:45], v[100:101] op_sel:[1,0,0] neg_lo:[1,0,0] neg_hi:[1,0,0]
    v_pk_fma_f32 v[46:47], v[24:25], v[44:45], v[46:47] op_sel_hi:[0,1,1]
    v_pk_fma_f32 v[62:63], v[24:25], v[60:61], v[62:63] op_sel_hi:[0,1,1]
    v_pk_fma_f32 v[46:47], v[24:25], v[60:61], v[46:47] op_sel:[1,0,0] neg_lo:[1,0,0] neg_hi:[1,0,0]
    v_pk_fma_f32 v[62:63], v[24:25], v[44:45], v[62:63] op_sel:[1,0,0]
    v_pk_mul_f32 v[86:87], v[118:119], v[46:47] op_sel_hi:[0,1]
    v_pk_mul_f32 v[102:103], v[118:119], v[62:63] op_sel_hi:[0,1] neg_lo:[1,0] neg_hi:[1,0]
    v_pk_fma_f32 v[86:87], v[118:119], v[62:63], v[86:87] op_sel:[1,0,0] neg_lo:[1,0,0] neg_hi:[1,0,0]
    v_pk_fma_f32 v[102:103], v[118:119], v[46:47], v[102:103] op_sel:[1,0,0] neg_lo:[1,0,0] neg_hi:[1,0,0]
    v_cvt_pk_bf16_f32 v48, v72, v74
    v_cvt_pk_bf16_f32 v49, v76, v78
    v_cvt_pk_bf16_f32 v50, v80, v82
    v_cvt_pk_bf16_f32 v51, v84, v86
    v_cvt_pk_bf16_f32 v52, v73, v75
    v_cvt_pk_bf16_f32 v53, v77, v79
    v_cvt_pk_bf16_f32 v54, v81, v83
    v_cvt_pk_bf16_f32 v55, v85, v87
    v_cvt_pk_bf16_f32 v56, v88, v90
    v_cvt_pk_bf16_f32 v57, v92, v94
    v_cvt_pk_bf16_f32 v58, v96, v98
    v_cvt_pk_bf16_f32 v59, v100, v102
    v_cvt_pk_bf16_f32 v60, v89, v91
    v_cvt_pk_bf16_f32 v61, v93, v95
    v_cvt_pk_bf16_f32 v62, v97, v99
    v_cvt_pk_bf16_f32 v63, v101, v103
    ds_write_b128 v17, v[48:51] offset:0
    ds_write_b128 v17, v[52:55] offset:128
    ds_write_b128 v17, v[56:59] offset:2048
    ds_write_b128 v17, v[60:63] offset:2176
    s_lshl_b32 s8, s10, 2
    s_add_u32 s8, s8, s3
    s_mul_i32 s12, s8, 57344
    s_lshl_b32 s14, s11, 11
    s_add_u32 s12, s12, s14
    s_add_u32 s12, s12, 2621440
    s_add_u32 s14, s12, 28672
    s_lshl_b32 s8, s8, 4
    s_add_u32 s8, s8, s11
    s_lshl_b32 s8, s8, 7
    s_add_u32 s63, s8, 458752
    s_waitcnt lgkmcnt(0)
    ds_read_b64_tr_b16 v[72:73], v20 offset:0
    ds_read_b64_tr_b16 v[74:75], v20 offset:256
    ds_read_b64_tr_b16 v[76:77], v20 offset:1024
    ds_read_b64_tr_b16 v[78:79], v20 offset:1280
    ds_read_b64_tr_b16 v[80:81], v20 offset:2048
    ds_read_b64_tr_b16 v[82:83], v20 offset:2304
    ds_read_b64_tr_b16 v[84:85], v20 offset:3072
    ds_read_b64_tr_b16 v[86:87], v20 offset:3328
    v_lshlrev_b32 v4, 4, v1
    s_waitcnt lgkmcnt(0)
    buffer_store_dwordx4 v[72:75], v4, s[64:67], s12 offen sc1
    buffer_store_dwordx4 v[76:79], v4, s[64:67], s12 offen offset:1024 sc1
    buffer_store_dwordx4 v[80:83], v4, s[64:67], s14 offen sc1
    buffer_store_dwordx4 v[84:87], v4, s[64:67], s14 offen offset:1024 sc1
    s_and_b32 s10, s3, 1
    s_lshr_b32 s11, s3, 1
    s_mov_b32 s72, s32
    s_mov_b32 s73, s33
    s_mov_b32 s74, 0x380
    s_mov_b32 s75, 0x00020000
    v_pk_mul_f32 v[8:9], v[126:127], 0 op_sel:[1,0]
    v_pk_mul_f32 v[10:11], v[126:127], 0 op_sel:[1,0]
    v_pk_mul_f32 v[12:13], v[126:127], 0 op_sel:[1,0]
    v_pk_mul_f32 v[14:15], v[126:127], 0 op_sel:[1,0]
    v_pk_mul_f32 v[16:17], v[126:127], 0 op_sel:[1,0]
    v_pk_mul_f32 v[18:19], v[126:127], 0 op_sel:[1,0]
    v_pk_mul_f32 v[20:21], v[126:127], 0 op_sel:[1,0]
    v_pk_mul_f32 v[22:23], v[126:127], 0 op_sel:[1,0]
    v_mov_b32 v120, 0
    v_lshrrev_b32 v5, 5, v1
    v_mul_u32_u24 v122, 14336, v5
    v_mul_u32_u24 v5, 3584, v5
    v_and_b32 v6, 31, v1
    v_lshl_add_u32 v122, v6, 2, v122
    v_lshl_add_u32 v5, v6, 1, v5
    v_lshlrev_b32 v6, 1, v6
    s_lshl_b32 s8, s6, 1
    s_add_u32 s8, s8, s10
    s_mul_i32 s62, s8, 114688
    s_mul_i32 s14, s8, 28672
    s_mul_i32 s12, s8, 57344
    s_xor_b32 s8, s8, 1
    s_mul_i32 s13, s8, 57344
    s_lshl_b32 s8, s7, 1
    s_add_u32 s8, s8, s11
    s_mul_i32 s60, s8, 57344
    s_xor_b32 s15, s8, 1
    s_mul_i32 s61, s15, 57344
    s_lshl_b32 s8, s8, 6
    s_add_u32 s14, s14, s8
    s_mul_i32 s15, s3, 14336
    v_add_u32 v2, s15, v4
    v_add_u32 v3, 6422528, v2
    v_add_u32 v2, 2621440, v2
    s_waitcnt vmcnt(0)
    s_mov_b64 exec, 1
    buffer_store_dwordx2 v[124:125], v127, s[64:67], s63 offen sc1
    s_mov_b64 exec, -1
    buffer_load_short_d16_hi v120, v6, s[72:75], s8 offen
    s_lshl_b32 s8, s8, 1
    s_add_u32 s62, s62, s8
    buffer_load_short_d16_hi v8, v5, s[52:55], s14 offen offset:0
    buffer_load_short_d16_hi v9, v5, s[52:55], s14 offen offset:896
    buffer_load_short_d16_hi v10, v5, s[52:55], s14 offen offset:1792
    buffer_load_short_d16_hi v11, v5, s[52:55], s14 offen offset:2688
    s_add_u32 s14, s14, 0x3800
    buffer_load_short_d16_hi v12, v5, s[52:55], s14 offen offset:0
    buffer_load_short_d16_hi v13, v5, s[52:55], s14 offen offset:896
    buffer_load_short_d16_hi v14, v5, s[52:55], s14 offen offset:1792
    buffer_load_short_d16_hi v15, v5, s[52:55], s14 offen offset:2688
    s_add_u32 s14, s14, 0xffffe400
    buffer_load_short_d16_hi v16, v5, s[52:55], s14 offen offset:0
    buffer_load_short_d16_hi v17, v5, s[52:55], s14 offen offset:896
    buffer_load_short_d16_hi v18, v5, s[52:55], s14 offen offset:1792
    buffer_load_short_d16_hi v19, v5, s[52:55], s14 offen offset:2688
    s_add_u32 s14, s14, 0x3800
    buffer_load_short_d16_hi v20, v5, s[52:55], s14 offen offset:0
    buffer_load_short_d16_hi v21, v5, s[52:55], s14 offen offset:896
    buffer_load_short_d16_hi v22, v5, s[52:55], s14 offen offset:1792
    buffer_load_short_d16_hi v23, v5, s[52:55], s14 offen offset:2688
    s_and_b32 s8, s3, 1
    s_mul_i32 s8, s8, 896
    s_lshl_b32 s14, s6, 12
    s_add_u32 s8, s8, s14
    s_add_u32 s8, s8, 458752
    v_lshlrev_b32 v6, 7, v1
    v_add_u32 v7, s8, v6
    s_mul_i32 s8, s11, 14
    s_lshl_b32 s14, s7, 1
    s_add_u32 s8, s8, s14
    s_lshl_b32 s8, s8, 7
    s_add_u32 s8, s8, 356352
    s_mov_b32 exec_lo, 0
    v_add_u32 v7, s8, v6
    s_mov_b32 exec_lo, -1
    s_mov_b32 s100, 0
    s_mov_b32 exec_lo, 0x007f007f
    s_mov_b32 exec_hi, 3
fp_31:
    buffer_load_dwordx2 v[72:73], v7, s[64:67], 0 offen sc1
    s_waitcnt vmcnt(0)
    v_cmp_ne_u64 vcc, v[72:73], v[124:125]
    s_cbranch_vccz fp_32
    s_sleep 1
    s_add_u32 s100, s100, 1
    s_cmp_lt_u32 s100, 2097152
    s_cbranch_scc1 fp_31
fp_32:
    s_mov_b64 exec, -1
    s_setprio 0
    buffer_load_dwordx4 v[72:75], v2, s[64:67], s12 offen offset:0 sc1
    buffer_load_dwordx4 v[80:83], v3, s[64:67], s60 offen offset:0 sc1
    buffer_load_dwordx4 v[76:79], v2, s[64:67], s13 offen offset:0 sc1
    buffer_load_dwordx4 v[84:87], v3, s[64:67], s61 offen offset:0 sc1
    buffer_load_dwordx4 v[88:91], v2, s[64:67], s12 offen offset:1024 sc1
    buffer_load_dwordx4 v[96:99], v3, s[64:67], s60 offen offset:1024 sc1
    buffer_load_dwordx4 v[92:95], v2, s[64:67], s13 offen offset:1024 sc1
    buffer_load_dwordx4 v[100:103], v3, s[64:67], s61 offen offset:1024 sc1
    buffer_load_dwordx4 v[104:107], v2, s[64:67], s12 offen offset:2048 sc1
    buffer_load_dwordx4 v[112:115], v3, s[64:67], s60 offen offset:2048 sc1
    buffer_load_dwordx4 v[108:111], v2, s[64:67], s13 offen offset:2048 sc1
    buffer_load_dwordx4 v[116:119], v3, s[64:67], s61 offen offset:2048 sc1
    v_pk_mul_f32 v[8:9], v[8:9], v[120:121] op_sel_hi:[1,0]
    v_pk_mul_f32 v[10:11], v[10:11], v[120:121] op_sel_hi:[1,0]
    v_pk_mul_f32 v[12:13], v[12:13], v[120:121] op_sel_hi:[1,0]
    v_pk_mul_f32 v[14:15], v[14:15], v[120:121] op_sel_hi:[1,0]
    v_pk_mul_f32 v[16:17], v[16:17], v[120:121] op_sel_hi:[1,0]
    v_pk_mul_f32 v[18:19], v[18:19], v[120:121] op_sel_hi:[1,0]
    v_pk_mul_f32 v[20:21], v[20:21], v[120:121] op_sel_hi:[1,0]
    v_pk_mul_f32 v[22:23], v[22:23], v[120:121] op_sel_hi:[1,0]
    s_mov_b32 s72, s44
    s_mov_b32 s73, s45
    s_mov_b32 s74, 0x700000
    s_mov_b32 s75, 0x00020000
    s_waitcnt vmcnt(8)
    v_mfma_f32_32x32x16_bf16 v[8:23], v[72:75], v[80:83], v[8:23]
    v_mfma_f32_32x32x16_bf16 v[40:55], v[76:79], v[80:83], 0
    v_mfma_f32_32x32x16_bf16 v[24:39], v[72:75], v[84:87], 0
    v_mfma_f32_32x32x16_bf16 v[56:71], v[76:79], v[84:87], 0
    buffer_load_dwordx4 v[72:75], v2, s[64:67], s12 offen offset:3072 sc1
    buffer_load_dwordx4 v[80:83], v3, s[64:67], s60 offen offset:3072 sc1
    buffer_load_dwordx4 v[76:79], v2, s[64:67], s13 offen offset:3072 sc1
    buffer_load_dwordx4 v[84:87], v3, s[64:67], s61 offen offset:3072 sc1
    v_add_u32 v2, 0x1000, v2
    v_add_u32 v3, 0x1000, v3
    s_waitcnt vmcnt(8)
    v_mfma_f32_32x32x16_bf16 v[8:23], v[88:91], v[96:99], v[8:23]
    v_mfma_f32_32x32x16_bf16 v[40:55], v[92:95], v[96:99], v[40:55]
    v_mfma_f32_32x32x16_bf16 v[24:39], v[88:91], v[100:103], v[24:39]
    v_mfma_f32_32x32x16_bf16 v[56:71], v[92:95], v[100:103], v[56:71]
    buffer_load_dwordx4 v[88:91], v2, s[64:67], s12 offen offset:0 sc1
    buffer_load_dwordx4 v[96:99], v3, s[64:67], s60 offen offset:0 sc1
    buffer_load_dwordx4 v[92:95], v2, s[64:67], s13 offen offset:0 sc1
    buffer_load_dwordx4 v[100:103], v3, s[64:67], s61 offen offset:0 sc1
    s_waitcnt vmcnt(8)
    v_mfma_f32_32x32x16_bf16 v[8:23], v[104:107], v[112:115], v[8:23]
    v_mfma_f32_32x32x16_bf16 v[40:55], v[108:111], v[112:115], v[40:55]
    v_mfma_f32_32x32x16_bf16 v[24:39], v[104:107], v[116:119], v[24:39]
    v_mfma_f32_32x32x16_bf16 v[56:71], v[108:111], v[116:119], v[56:71]
    buffer_load_dwordx4 v[104:107], v2, s[64:67], s12 offen offset:1024 sc1
    buffer_load_dwordx4 v[112:115], v3, s[64:67], s60 offen offset:1024 sc1
    buffer_load_dwordx4 v[108:111], v2, s[64:67], s13 offen offset:1024 sc1
    buffer_load_dwordx4 v[116:119], v3, s[64:67], s61 offen offset:1024 sc1
    s_waitcnt vmcnt(8)
    v_mfma_f32_32x32x16_bf16 v[8:23], v[72:75], v[80:83], v[8:23]
    v_mfma_f32_32x32x16_bf16 v[40:55], v[76:79], v[80:83], v[40:55]
    v_mfma_f32_32x32x16_bf16 v[24:39], v[72:75], v[84:87], v[24:39]
    v_mfma_f32_32x32x16_bf16 v[56:71], v[76:79], v[84:87], v[56:71]
    buffer_load_dwordx4 v[72:75], v2, s[64:67], s12 offen offset:2048 sc1
    buffer_load_dwordx4 v[80:83], v3, s[64:67], s60 offen offset:2048 sc1
    buffer_load_dwordx4 v[76:79], v2, s[64:67], s13 offen offset:2048 sc1
    buffer_load_dwordx4 v[84:87], v3, s[64:67], s61 offen offset:2048 sc1
    s_waitcnt vmcnt(8)
    v_mfma_f32_32x32x16_bf16 v[8:23], v[88:91], v[96:99], v[8:23]
    v_mfma_f32_32x32x16_bf16 v[40:55], v[92:95], v[96:99], v[40:55]
    v_mfma_f32_32x32x16_bf16 v[24:39], v[88:91], v[100:103], v[24:39]
    v_mfma_f32_32x32x16_bf16 v[56:71], v[92:95], v[100:103], v[56:71]
    buffer_load_dwordx4 v[88:91], v2, s[64:67], s12 offen offset:3072 sc1
    buffer_load_dwordx4 v[96:99], v3, s[64:67], s60 offen offset:3072 sc1
    buffer_load_dwordx4 v[92:95], v2, s[64:67], s13 offen offset:3072 sc1
    buffer_load_dwordx4 v[100:103], v3, s[64:67], s61 offen offset:3072 sc1
    v_add_u32 v2, 0x1000, v2
    v_add_u32 v3, 0x1000, v3
    s_waitcnt vmcnt(8)
    v_mfma_f32_32x32x16_bf16 v[8:23], v[104:107], v[112:115], v[8:23]
    v_mfma_f32_32x32x16_bf16 v[40:55], v[108:111], v[112:115], v[40:55]
    v_mfma_f32_32x32x16_bf16 v[24:39], v[104:107], v[116:119], v[24:39]
    v_mfma_f32_32x32x16_bf16 v[56:71], v[108:111], v[116:119], v[56:71]
    buffer_load_dwordx4 v[104:107], v2, s[64:67], s12 offen offset:0 sc1
    buffer_load_dwordx4 v[112:115], v3, s[64:67], s60 offen offset:0 sc1
    buffer_load_dwordx4 v[108:111], v2, s[64:67], s13 offen offset:0 sc1
    buffer_load_dwordx4 v[116:119], v3, s[64:67], s61 offen offset:0 sc1
    s_waitcnt vmcnt(8)
    v_mfma_f32_32x32x16_bf16 v[8:23], v[72:75], v[80:83], v[8:23]
    v_mfma_f32_32x32x16_bf16 v[40:55], v[76:79], v[80:83], v[40:55]
    v_mfma_f32_32x32x16_bf16 v[24:39], v[72:75], v[84:87], v[24:39]
    v_mfma_f32_32x32x16_bf16 v[56:71], v[76:79], v[84:87], v[56:71]
    buffer_load_dwordx4 v[72:75], v2, s[64:67], s12 offen offset:1024 sc1
    buffer_load_dwordx4 v[80:83], v3, s[64:67], s60 offen offset:1024 sc1
    buffer_load_dwordx4 v[76:79], v2, s[64:67], s13 offen offset:1024 sc1
    buffer_load_dwordx4 v[84:87], v3, s[64:67], s61 offen offset:1024 sc1
    s_waitcnt vmcnt(8)
    v_mfma_f32_32x32x16_bf16 v[8:23], v[88:91], v[96:99], v[8:23]
    v_mfma_f32_32x32x16_bf16 v[40:55], v[92:95], v[96:99], v[40:55]
    v_mfma_f32_32x32x16_bf16 v[24:39], v[88:91], v[100:103], v[24:39]
    v_mfma_f32_32x32x16_bf16 v[56:71], v[92:95], v[100:103], v[56:71]
    buffer_load_dwordx4 v[88:91], v2, s[64:67], s12 offen offset:2048 sc1
    buffer_load_dwordx4 v[96:99], v3, s[64:67], s60 offen offset:2048 sc1
    buffer_load_dwordx4 v[92:95], v2, s[64:67], s13 offen offset:2048 sc1
    buffer_load_dwordx4 v[100:103], v3, s[64:67], s61 offen offset:2048 sc1
    s_waitcnt vmcnt(8)
    v_mfma_f32_32x32x16_bf16 v[8:23], v[104:107], v[112:115], v[8:23]
    v_mfma_f32_32x32x16_bf16 v[40:55], v[108:111], v[112:115], v[40:55]
    v_mfma_f32_32x32x16_bf16 v[24:39], v[104:107], v[116:119], v[24:39]
    v_mfma_f32_32x32x16_bf16 v[56:71], v[108:111], v[116:119], v[56:71]
    buffer_load_dwordx4 v[104:107], v2, s[64:67], s12 offen offset:3072 sc1
    buffer_load_dwordx4 v[112:115], v3, s[64:67], s60 offen offset:3072 sc1
    buffer_load_dwordx4 v[108:111], v2, s[64:67], s13 offen offset:3072 sc1
    buffer_load_dwordx4 v[116:119], v3, s[64:67], s61 offen offset:3072 sc1
    v_add_u32 v2, 0x1000, v2
    v_add_u32 v3, 0x1000, v3
    s_waitcnt vmcnt(8)
    v_mfma_f32_32x32x16_bf16 v[8:23], v[72:75], v[80:83], v[8:23]
    v_mfma_f32_32x32x16_bf16 v[40:55], v[76:79], v[80:83], v[40:55]
    v_mfma_f32_32x32x16_bf16 v[24:39], v[72:75], v[84:87], v[24:39]
    v_mfma_f32_32x32x16_bf16 v[56:71], v[76:79], v[84:87], v[56:71]
    buffer_load_dwordx4 v[72:75], v2, s[64:67], s12 offen offset:0 sc1
    buffer_load_dwordx4 v[80:83], v3, s[64:67], s60 offen offset:0 sc1
    buffer_load_dwordx4 v[76:79], v2, s[64:67], s13 offen offset:0 sc1
    buffer_load_dwordx4 v[84:87], v3, s[64:67], s61 offen offset:0 sc1
    s_waitcnt vmcnt(8)
    v_mfma_f32_32x32x16_bf16 v[8:23], v[88:91], v[96:99], v[8:23]
    v_mfma_f32_32x32x16_bf16 v[40:55], v[92:95], v[96:99], v[40:55]
    v_mfma_f32_32x32x16_bf16 v[24:39], v[88:91], v[100:103], v[24:39]
    v_mfma_f32_32x32x16_bf16 v[56:71], v[92:95], v[100:103], v[56:71]
    buffer_load_dwordx4 v[88:91], v2, s[64:67], s12 offen offset:1024 sc1
    buffer_load_dwordx4 v[96:99], v3, s[64:67], s60 offen offset:1024 sc1
    buffer_load_dwordx4 v[92:95], v2, s[64:67], s13 offen offset:1024 sc1
    buffer_load_dwordx4 v[100:103], v3, s[64:67], s61 offen offset:1024 sc1
    s_waitcnt vmcnt(8)
    v_mfma_f32_32x32x16_bf16 v[8:23], v[104:107], v[112:115], v[8:23]
    v_mfma_f32_32x32x16_bf16 v[40:55], v[108:111], v[112:115], v[40:55]
    v_mfma_f32_32x32x16_bf16 v[24:39], v[104:107], v[116:119], v[24:39]
    v_mfma_f32_32x32x16_bf16 v[56:71], v[108:111], v[116:119], v[56:71]
    s_waitcnt vmcnt(4)
    v_mfma_f32_32x32x16_bf16 v[8:23], v[72:75], v[80:83], v[8:23]
    v_mfma_f32_32x32x16_bf16 v[40:55], v[76:79], v[80:83], v[40:55]
    v_mfma_f32_32x32x16_bf16 v[24:39], v[72:75], v[84:87], v[24:39]
    v_mfma_f32_32x32x16_bf16 v[56:71], v[76:79], v[84:87], v[56:71]
    s_waitcnt vmcnt(0)
    v_mfma_f32_32x32x16_bf16 v[8:23], v[88:91], v[96:99], v[8:23]
    v_mfma_f32_32x32x16_bf16 v[40:55], v[92:95], v[96:99], v[40:55]
    v_mfma_f32_32x32x16_bf16 v[24:39], v[88:91], v[100:103], v[24:39]
    v_mfma_f32_32x32x16_bf16 v[56:71], v[92:95], v[100:103], v[56:71]
    v_lshlrev_b32 v4, 4, v1
    s_xor_b32 s8, s3, 1
    s_mul_i32 s8, s8, 12288
    s_add_u32 s8, s8, 0
    v_add_u32 v5, s8, v4
    s_xor_b32 s8, s3, 2
    s_mul_i32 s8, s8, 12288
    s_add_u32 s8, s8, 4096
    v_add_u32 v6, s8, v4
    s_xor_b32 s8, s3, 3
    s_mul_i32 s8, s8, 12288
    s_add_u32 s8, s8, 8192
    v_add_u32 v7, s8, v4
    s_mul_i32 s8, s3, 12288
    v_add_u32 v4, s8, v4
    s_barrier
    ds_write_b128 v5, v[40:43] offset:0
    ds_write_b128 v5, v[44:47] offset:1024
    ds_write_b128 v5, v[48:51] offset:2048
    ds_write_b128 v5, v[52:55] offset:3072
    ds_write_b128 v6, v[24:27] offset:0
    ds_write_b128 v6, v[28:31] offset:1024
    ds_write_b128 v6, v[32:35] offset:2048
    ds_write_b128 v6, v[36:39] offset:3072
    ds_write_b128 v7, v[56:59] offset:0
    ds_write_b128 v7, v[60:63] offset:1024
    ds_write_b128 v7, v[64:67] offset:2048
    ds_write_b128 v7, v[68:71] offset:3072
    s_waitcnt lgkmcnt(0)
    s_barrier
    ds_read_b128 v[72:75], v4 offset:0
    ds_read_b128 v[76:79], v4 offset:1024
    ds_read_b128 v[80:83], v4 offset:2048
    ds_read_b128 v[84:87], v4 offset:3072
    ds_read_b128 v[88:91], v4 offset:4096
    ds_read_b128 v[92:95], v4 offset:5120
    ds_read_b128 v[96:99], v4 offset:6144
    ds_read_b128 v[100:103], v4 offset:7168
    ds_read_b128 v[104:107], v4 offset:8192
    ds_read_b128 v[108:111], v4 offset:9216
    ds_read_b128 v[112:115], v4 offset:10240
    ds_read_b128 v[116:119], v4 offset:11264
    s_waitcnt lgkmcnt(8)
    v_pk_add_f32 v[8:9], v[8:9], v[72:73]
    v_pk_add_f32 v[10:11], v[10:11], v[74:75]
    v_pk_add_f32 v[12:13], v[12:13], v[76:77]
    v_pk_add_f32 v[14:15], v[14:15], v[78:79]
    v_pk_add_f32 v[16:17], v[16:17], v[80:81]
    v_pk_add_f32 v[18:19], v[18:19], v[82:83]
    v_pk_add_f32 v[20:21], v[20:21], v[84:85]
    v_pk_add_f32 v[22:23], v[22:23], v[86:87]
    s_waitcnt lgkmcnt(4)
    v_pk_add_f32 v[8:9], v[8:9], v[88:89]
    v_pk_add_f32 v[10:11], v[10:11], v[90:91]
    v_pk_add_f32 v[12:13], v[12:13], v[92:93]
    v_pk_add_f32 v[14:15], v[14:15], v[94:95]
    v_pk_add_f32 v[16:17], v[16:17], v[96:97]
    v_pk_add_f32 v[18:19], v[18:19], v[98:99]
    v_pk_add_f32 v[20:21], v[20:21], v[100:101]
    v_pk_add_f32 v[22:23], v[22:23], v[102:103]
    s_waitcnt lgkmcnt(0)
    v_pk_add_f32 v[8:9], v[8:9], v[104:105]
    v_pk_add_f32 v[10:11], v[10:11], v[106:107]
    v_pk_add_f32 v[12:13], v[12:13], v[108:109]
    v_pk_add_f32 v[14:15], v[14:15], v[110:111]
    v_pk_add_f32 v[16:17], v[16:17], v[112:113]
    v_pk_add_f32 v[18:19], v[18:19], v[114:115]
    v_pk_add_f32 v[20:21], v[20:21], v[116:117]
    v_pk_add_f32 v[22:23], v[22:23], v[118:119]
    s_add_u32 s14, s62, 0
    buffer_store_dword v8, v122, s[72:75], s14 offen nt
    s_add_u32 s14, s62, 3584
    buffer_store_dword v9, v122, s[72:75], s14 offen nt
    s_add_u32 s14, s62, 7168
    buffer_store_dword v10, v122, s[72:75], s14 offen nt
    s_add_u32 s14, s62, 10752
    buffer_store_dword v11, v122, s[72:75], s14 offen nt
    s_add_u32 s14, s62, 57344
    buffer_store_dword v12, v122, s[72:75], s14 offen nt
    s_add_u32 s14, s62, 60928
    buffer_store_dword v13, v122, s[72:75], s14 offen nt
    s_add_u32 s14, s62, 64512
    buffer_store_dword v14, v122, s[72:75], s14 offen nt
    s_add_u32 s14, s62, 68096
    buffer_store_dword v15, v122, s[72:75], s14 offen nt
    s_add_u32 s14, s62, 28672
    buffer_store_dword v16, v122, s[72:75], s14 offen nt
    s_add_u32 s14, s62, 32256
    buffer_store_dword v17, v122, s[72:75], s14 offen nt
    s_add_u32 s14, s62, 35840
    buffer_store_dword v18, v122, s[72:75], s14 offen nt
    s_add_u32 s14, s62, 39424
    buffer_store_dword v19, v122, s[72:75], s14 offen nt
    s_add_u32 s14, s62, 86016
    buffer_store_dword v20, v122, s[72:75], s14 offen nt
    s_add_u32 s14, s62, 89600
    buffer_store_dword v21, v122, s[72:75], s14 offen nt
    s_add_u32 s14, s62, 93184
    buffer_store_dword v22, v122, s[72:75], s14 offen nt
    s_add_u32 s14, s62, 96768
    buffer_store_dword v23, v122, s[72:75], s14 offen nt
    s_endpgm
L_fin:
L_exit:
    s_endpgm
CODE_END:
.section .rodata,"a"
.p2align 6
.amdhsa_kernel concat_heads__ssm_conv_s5__grouped_kv_mqa__prompt_kernel
  .amdhsa_next_free_vgpr 128
  .amdhsa_next_free_sgpr 102
  .amdhsa_accum_offset 128
  .amdhsa_group_segment_fixed_size 0
  .amdhsa_kernarg_size 136
  .amdhsa_user_sgpr_count 2
  .amdhsa_user_sgpr_kernarg_segment_ptr 1
  .amdhsa_system_sgpr_workgroup_id_x 1
.end_amdhsa_kernel
```
